```python
import torch

def _softmax(x, axis=-1):
    return torch.softmax(x, dim=axis)
def _gelu(x):
    return torch.nn.functional.gelu(x, approximate="tanh")
def _silu(x):
    return torch.nn.functional.silu(x)
def _sigmoid(x):
    return torch.sigmoid(x)
def _layernorm(x, axis=-1, eps=1e-5):
    m = x.mean(dim=axis, keepdim=True)
    v = x.var(dim=axis, keepdim=True, unbiased=False)
    return (x - m) / torch.sqrt(v + eps)
def _scatter_add(tgt, idx, src, axis=0):
    return tgt.clone().index_add_(axis, idx, src)
def _segment_sum(src, seg, n):
    out = torch.zeros((n,) + src.shape[1:], dtype=src.dtype)
    return out.index_add_(0, seg, src)
def _pad(x, pw):
    flat = tuple(v for pair in reversed(pw) for v in pair)
    return torch.nn.functional.pad(x, flat)

kernel_name = 'standalone__moe_arch_mod__prompt'

def setup_inputs():

    _w = (lambda a: (lambda t: t.to(torch.bfloat16) if t.is_floating_point() else t)(torch.as_tensor(a)))
    B, S, D, F, C = 1, 2048, 576, 4608, 8
    return {
        "x": _w((lambda *s: torch.randn(*s, dtype=torch.bfloat16) * 0.1)(B, S, D)),
        "w_r": _w((lambda *s: torch.randn(*s, dtype=torch.bfloat16) * 0.1)(D)),
        "w_gate": _w((lambda *s: torch.randn(*s, dtype=torch.bfloat16) * 0.1)(D, F)),
        "w_up": _w((lambda *s: torch.randn(*s, dtype=torch.bfloat16) * 0.1)(D, F)),
        "w_down": _w((lambda *s: torch.randn(*s, dtype=torch.bfloat16) * 0.1)(F, D)),
    }

def reference(x, w_r, w_gate, w_up, w_down):
    B, S, D = x.shape
    C = 8
    r = x @ w_r
    idx = torch.argsort(-r, axis=-1)[:, :C]
    idx_e = (lambda x, n, axis: torch.repeat_interleave(x, n, dim=axis))(idx.reshape(B, C, 1), D, axis=2)
    x_sel = (lambda x, i, axis: torch.take_along_dim(x, i, dim=axis))(x, idx_e, axis=1)
    g = _silu(x_sel @ w_gate)
    u = x_sel @ w_up
    y = (g * u) @ w_down
    r_sel = _sigmoid((lambda x, i, axis: torch.take_along_dim(x, i, dim=axis))(r, idx, axis=1))
    y = y * r_sel.reshape(B, C, 1)
    b_off = (torch.arange(B) * S).reshape(B, 1)
    flat_idx = (idx + b_off).reshape(B * C)
    zero = (x * 0.0).reshape(B * S, D)
    upd = _scatter_add(zero, flat_idx, y.reshape(B * C, D), axis=0)
    return x + upd.reshape(B, S, D)
```

```asm
; @launch grid=(256,1,1) block=(256,1,1) lds=13248
.amdgcn_target "amdgcn-amd-amdhsa--gfx950"
.text
.globl standalone__moe_arch_mod__prompt_kernel
.p2align 8
.type standalone__moe_arch_mod__prompt_kernel,@function
standalone__moe_arch_mod__prompt_kernel:
  s_cmp_ge_u32 s2, 256
  s_cbranch_scc1 L_end
  s_load_dwordx16 s[4:19], s[0:1], 0
  s_sub_u32 s3, s2, 232
  s_cmp_ge_u32 s3, 16
  s_cbranch_scc1 L_nocpe
  s_getpc_b64 s[24:25]
L_pc0:
  s_sub_u32 s24, s24, L_pc0-standalone__moe_arch_mod__prompt_kernel
  s_subb_u32 s25, s25, 0
  v_lshlrev_b32 v8, 6, v0
  v_min_u32 v8, L_slow-standalone__moe_arch_mod__prompt_kernel, v8
  global_load_dword v29, v8, s[24:25]
L_nocpe:
  v_lshrrev_b32 v1, 6, v0
  v_and_b32 v2, 7, v0
  v_readfirstlane_b32 s20, v1
  s_lshr_b32 s21, s2, 3
  s_and_b32 s22, s2, 7
  v_and_b32 v1, 63, v0
  v_lshrrev_b32 v3, 3, v1
  s_mov_b32 s59, 0
  s_mov_b32 s37, 0
  s_mov_b32 s30, 399999
  v_mov_b32 v20, 0
  v_mov_b32 v24, 0
  v_mov_b32 v25, 0
  v_mov_b32 v28, 0
  s_cmp_lg_u32 s20, 0
  s_cbranch_scc1 L_waves
  s_setprio 3
  v_lshlrev_b32 v80, 4, v2
  v_lshlrev_b32 v82, 4, v1
  s_lshl_b32 s3, s2, 3
  v_add_u32 v81, s3, v3
  v_mul_u32_u24 v4, 1152, v81
  v_add_u32 v4, v4, v80
  v_mov_b32 v84, -1
  v_mov_b32 v85, -1
  v_mov_b32 v86, -1
  v_mov_b32 v87, -1
  s_waitcnt lgkmcnt(0)
  global_load_dwordx4 v[44:47], v82, s[6:7]
  global_load_dwordx4 v[48:51], v80, s[6:7] offset:1024
  global_load_dwordx4 v[88:91], v4, s[4:5] offset:0 nt
  global_load_dwordx4 v[92:95], v4, s[4:5] offset:128 nt
  global_load_dwordx4 v[96:99], v4, s[4:5] offset:256 nt
  global_load_dwordx4 v[100:103], v4, s[4:5] offset:384 nt
  global_load_dwordx4 v[104:107], v4, s[4:5] offset:512 nt
  global_load_dwordx4 v[108:111], v4, s[4:5] offset:640 nt
  global_load_dwordx4 v[112:115], v4, s[4:5] offset:768 nt
  global_load_dwordx4 v[116:119], v4, s[4:5] offset:896 nt
  global_load_dwordx4 v[120:123], v4, s[4:5] offset:1024 nt
  s_load_dword s23, s[18:19], 0
  s_waitcnt vmcnt(10)
  ds_write_b128 v82, v[44:47] offset:12096
  s_waitcnt vmcnt(9)
  ds_write_b128 v80, v[48:51] offset:13120
  s_waitcnt lgkmcnt(0)
  ds_read_b128 v[44:47], v80 offset:12096
  ds_read_b128 v[48:51], v80 offset:12224
  ds_read_b128 v[52:55], v80 offset:12352
  ds_read_b128 v[56:59], v80 offset:12480
  ds_read_b128 v[60:63], v80 offset:12608
  ds_read_b128 v[64:67], v80 offset:12736
  ds_read_b128 v[68:71], v80 offset:12864
  ds_read_b128 v[72:75], v80 offset:12992
  ds_read_b128 v[76:79], v80 offset:13120
  v_mov_b32 v5, 0
  v_mov_b32 v6, 0
  v_sub_u32 v81, 2047, v81
  v_lshlrev_b32 v81, 5, v81
  s_lshl_b32 s3, s2, 4
  s_add_u32 s3, s3, 524288
  v_mul_u32_u24 v82, 4096, v2
  v_add_u32 v82, s3, v82
  s_waitcnt vmcnt(8) lgkmcnt(0)
  v_dot2c_f32_bf16 v5, v88, v44
  v_dot2c_f32_bf16 v6, v89, v45
  v_dot2c_f32_bf16 v5, v90, v46
  v_dot2c_f32_bf16 v6, v91, v47
  s_waitcnt vmcnt(7)
  v_dot2c_f32_bf16 v5, v92, v48
  v_dot2c_f32_bf16 v6, v93, v49
  v_dot2c_f32_bf16 v5, v94, v50
  v_dot2c_f32_bf16 v6, v95, v51
  s_waitcnt vmcnt(6)
  v_dot2c_f32_bf16 v5, v96, v52
  v_dot2c_f32_bf16 v6, v97, v53
  v_dot2c_f32_bf16 v5, v98, v54
  v_dot2c_f32_bf16 v6, v99, v55
  s_waitcnt vmcnt(5)
  v_dot2c_f32_bf16 v5, v100, v56
  v_dot2c_f32_bf16 v6, v101, v57
  v_dot2c_f32_bf16 v5, v102, v58
  v_dot2c_f32_bf16 v6, v103, v59
  s_waitcnt vmcnt(4)
  v_dot2c_f32_bf16 v5, v104, v60
  v_dot2c_f32_bf16 v6, v105, v61
  v_dot2c_f32_bf16 v5, v106, v62
  v_dot2c_f32_bf16 v6, v107, v63
  s_waitcnt vmcnt(3)
  v_dot2c_f32_bf16 v5, v108, v64
  v_dot2c_f32_bf16 v6, v109, v65
  v_dot2c_f32_bf16 v5, v110, v66
  v_dot2c_f32_bf16 v6, v111, v67
  s_waitcnt vmcnt(2)
  v_dot2c_f32_bf16 v5, v112, v68
  v_dot2c_f32_bf16 v6, v113, v69
  v_dot2c_f32_bf16 v5, v114, v70
  v_dot2c_f32_bf16 v6, v115, v71
  s_waitcnt vmcnt(1)
  v_dot2c_f32_bf16 v5, v116, v72
  v_dot2c_f32_bf16 v6, v117, v73
  v_dot2c_f32_bf16 v5, v118, v74
  v_dot2c_f32_bf16 v6, v119, v75
  s_waitcnt vmcnt(0)
  v_dot2c_f32_bf16 v5, v120, v76
  v_dot2c_f32_bf16 v6, v121, v77
  v_dot2c_f32_bf16 v5, v122, v78
  v_dot2c_f32_bf16 v6, v123, v79
  s_waitcnt lgkmcnt(0)
  s_add_u32 s23, s23, 2654435769
  s_mov_b32 s3, 0xffff0000
  v_add_f32 v5, v5, v6
  v_mov_b32 v47, s23
  v_mov_b32 v7, s23
  v_add_f32_dpp v5, v5, v5 quad_perm:[1,0,3,2] row_mask:0xf bank_mask:0xf
  s_nop 1
  v_add_f32_dpp v5, v5, v5 quad_perm:[2,3,0,1] row_mask:0xf bank_mask:0xf
  s_nop 1
  v_add_f32_dpp v5, v5, v5 row_half_mirror row_mask:0xf bank_mask:0xf
  v_cvt_pk_bf16_f32 v6, v5, v5
  v_cmp_u_f32 vcc, v5, v5
  v_ashrrev_i32 v48, 31, v6
  v_or_b32 v48, 0x80000000, v48
  v_xor_b32 v6, v6, v48
  v_cndmask_b32 v6, v6, 0, vcc
  v_and_or_b32 v6, v6, s3, v81
  s_nop 1
  v_max_u32_dpp v44, v6, v6 row_ror:8 row_mask:0xf bank_mask:0xf
  v_min_u32_dpp v45, v6, v6 row_ror:8 row_mask:0xf bank_mask:0xf
  s_nop 0
  v_min_u32_dpp v48, v44, v44 row_bcast:15 row_mask:0xa bank_mask:0xf
  v_max_u32_dpp v49, v45, v45 row_bcast:15 row_mask:0xa bank_mask:0xf
  v_max_u32_dpp v44, v44, v44 row_bcast:15 row_mask:0xa bank_mask:0xf
  v_max_u32 v45, v48, v49
  v_min_u32 v46, v48, v49
  v_min_u32_dpp v48, v44, v44 row_bcast:31 row_mask:0xc bank_mask:0xf
  v_max_u32_dpp v49, v45, v45 row_bcast:31 row_mask:0xc bank_mask:0xf
  v_max_u32_dpp v44, v44, v44 row_bcast:31 row_mask:0xc bank_mask:0xf
  v_max_u32_dpp v50, v46, v46 row_bcast:31 row_mask:0xc bank_mask:0xf
  v_max_u32 v45, v48, v49
  v_min_u32 v48, v48, v49
  v_max_u32 v46, v48, v50
  s_mov_b32 exec_lo, 0
  s_mov_b32 exec_hi, 0xff000000
  global_store_dwordx4 v82, v[44:47], s[18:19] sc1
  s_cmp_eq_u32 s21, 31
  s_cbranch_scc1 L_sel
  s_mov_b64 exec, -1
  s_setprio 0
  s_cmp_lt_u32 s21, 18
  s_cbranch_scc1 L_Gctl
  s_cmp_lt_u32 s21, 27
  s_cbranch_scc1 L_Dctl
  v_mov_b32 v74, 0
  ds_write_b32 v74, v7 offset:32
  s_waitcnt lgkmcnt(0)
  s_barrier
  s_barrier
L_Fres:
  s_lshl_b32 s3, s22, 7
  s_add_u32 s3, s3, 561152
  v_lshl_add_u32 v86, v2, 3, s3
L_pollR:
  global_load_dwordx2 v[72:73], v86, s[18:19] sc1
  s_sub_u32 s30, s30, 1
  s_cbranch_scc1 L_end
  s_waitcnt vmcnt(0)
  v_cmp_ne_u32 vcc, s23, v73
  s_cbranch_vccnz L_pollR
  v_min_u32_dpp v75, v72, v72 quad_perm:[1,0,3,2] row_mask:0xf bank_mask:0xf
  s_nop 1
  v_min_u32_dpp v75, v75, v75 quad_perm:[2,3,0,1] row_mask:0xf bank_mask:0xf
  s_nop 1
  v_min_u32_dpp v75, v75, v75 row_half_mirror row_mask:0xf bank_mask:0xf
L_copyT:
L_copy0:
  v_cmp_lt_u32 s[34:35], v6, v75
L_copy1:
  s_movk_i32 s3, 0x207
  v_cmp_class_f32 vcc, v5, s3
  s_cbranch_vccnz L_nanfix
L_copy:
  s_and_b64 exec, exec, s[34:35]
  s_cbranch_execz L_copied
  global_store_dwordx4 v4, v[88:91], s[14:15] offset:0 sc1
  global_store_dwordx4 v4, v[92:95], s[14:15] offset:128 sc1
  global_store_dwordx4 v4, v[96:99], s[14:15] offset:256 sc1
  global_store_dwordx4 v4, v[100:103], s[14:15] offset:384 sc1
  global_store_dwordx4 v4, v[104:107], s[14:15] offset:512 sc1
  global_store_dwordx4 v4, v[108:111], s[14:15] offset:640 sc1
  global_store_dwordx4 v4, v[112:115], s[14:15] offset:768 sc1
  global_store_dwordx4 v4, v[116:119], s[14:15] offset:896 sc1
  global_store_dwordx4 v4, v[120:123], s[14:15] offset:1024 sc1
L_copied:
L_fin:
L_end:
  s_endpgm
L_sel:
  s_mov_b64 exec, -1
  s_and_b32 s3, s22, 7
  s_mul_i32 s3, s3, 4096
  s_add_u32 s3, s3, 524288
  v_lshl_add_u32 v86, v0, 4, s3
  s_lshl_b32 s3, s22, 7
  s_add_u32 s3, s3, 557056
  v_lshl_add_u32 v84, v0, 4, s3
  v_add_u32 v85, 4096, v84
  v_mov_b32 v77, s23
  v_mov_b32 v79, s23
  v_lshlrev_b32 v87, 3, v0
  s_mov_b32 s24, 0x55555555
  s_mov_b32 s25, 0x55555555
  s_mov_b32 s26, 0x33333333
  s_mov_b32 s27, 0x33333333
  v_cndmask_b32 v60, 0, -1, s[24:25]
  v_cndmask_b32 v61, 0, -1, s[26:27]
  v_lshlrev_b32 v82, 7, v3
  v_add_u32 v82, 2358144, v82
  s_movk_i32 s58, -1152
  s_waitcnt vmcnt(0)
  s_mov_b64 s[40:41], -1
  s_mov_b64 s[42:43], -1
  s_mov_b64 s[44:45], -1
  s_mov_b64 s[46:47], -1
L_poll1:
  s_or_b32 s40, s40, 1
  s_or_b32 s42, s42, 1
  s_or_b32 s44, s44, 1
  s_or_b32 s46, s46, 1
  s_mov_b64 exec, s[40:41]
  global_load_dwordx4 v[124:127], v86, s[18:19] offset:0 sc1
  s_mov_b64 exec, s[42:43]
  global_load_dwordx4 v[128:131], v86, s[18:19] offset:1024 sc1
  s_mov_b64 exec, s[44:45]
  global_load_dwordx4 v[132:135], v86, s[18:19] offset:2048 sc1
  s_mov_b64 exec, s[46:47]
  global_load_dwordx4 v[136:139], v86, s[18:19] offset:3072 sc1
  s_mov_b64 exec, -1
  s_sub_u32 s30, s30, 1
  s_cbranch_scc1 L_end
  s_waitcnt vmcnt(0)
  v_cmp_ne_u32 s[40:41], s23, v127
  v_cmp_ne_u32 s[42:43], s23, v131
  v_cmp_ne_u32 s[44:45], s23, v135
  v_cmp_ne_u32 s[46:47], s23, v139
  s_or_b64 s[48:49], s[40:41], s[42:43]
  s_or_b64 s[50:51], s[44:45], s[46:47]
  s_or_b64 s[48:49], s[48:49], s[50:51]
  s_cbranch_scc1 L_poll1
  v_min_u32 v51, v124, v128
  v_max_u32 v55, v125, v129
  v_max_u32 v64, v124, v128
  v_max_u32 v65, v51, v55
  v_min_u32 v51, v51, v55
  v_max3_u32 v66, v51, v126, v130
  v_min_u32 v59, v132, v136
  v_max_u32 v63, v133, v137
  v_max_u32 v68, v132, v136
  v_max_u32 v69, v59, v63
  v_min_u32 v59, v59, v63
  v_max3_u32 v70, v59, v134, v138
  v_min_u32 v51, v64, v68
  v_max_u32 v55, v65, v69
  v_max_u32 v72, v64, v68
  v_max_u32 v73, v51, v55
  v_min_u32 v51, v51, v55
  v_max3_u32 v74, v51, v66, v70
  v_mov_b32_dpp v51, v72 quad_perm:[1,0,3,2] row_mask:0xf bank_mask:0xf
  v_mov_b32_dpp v50, v73 quad_perm:[1,0,3,2] row_mask:0xf bank_mask:0xf
  v_med3_u32 v48, v72, v50, v60
  v_med3_u32 v49, v73, v51, v60
  v_max_u32 v72, v48, v49
  v_min_u32 v73, v48, v49
  s_nop 0
  v_mov_b32_dpp v51, v72 quad_perm:[3,2,1,0] row_mask:0xf bank_mask:0xf
  v_mov_b32_dpp v50, v73 quad_perm:[3,2,1,0] row_mask:0xf bank_mask:0xf
  v_med3_u32 v48, v72, v50, v61
  v_med3_u32 v49, v73, v51, v61
  s_nop 0
  v_mov_b32_dpp v50, v48 quad_perm:[1,0,3,2] row_mask:0xf bank_mask:0xf
  v_mov_b32_dpp v51, v49 quad_perm:[1,0,3,2] row_mask:0xf bank_mask:0xf
  v_med3_u32 v52, v48, v50, v60
  v_med3_u32 v53, v49, v51, v60
  v_max_u32 v72, v52, v53
  v_min_u32 v73, v52, v53
  s_nop 0
  v_max_u32_dpp v49, v72, v73 row_half_mirror row_mask:0xf bank_mask:0xf
  v_max_u32_dpp v48, v73, v72 row_half_mirror row_mask:0xf bank_mask:0xf
  s_nop 1
  v_mov_b32_dpp v50, v48 quad_perm:[2,3,0,1] row_mask:0xf bank_mask:0xf
  v_mov_b32_dpp v51, v49 quad_perm:[2,3,0,1] row_mask:0xf bank_mask:0xf
  v_med3_u32 v72, v48, v50, v61
  v_med3_u32 v73, v49, v51, v61
  s_nop 0
  v_mov_b32_dpp v50, v72 quad_perm:[1,0,3,2] row_mask:0xf bank_mask:0xf
  v_mov_b32_dpp v51, v73 quad_perm:[1,0,3,2] row_mask:0xf bank_mask:0xf
  v_med3_u32 v48, v72, v50, v60
  v_med3_u32 v49, v73, v51, v60
  v_max_u32 v72, v48, v49
  v_min_u32 v73, v48, v49
  s_nop 0
  v_max_u32_dpp v49, v72, v73 row_mirror row_mask:0xf bank_mask:0xf
  v_max_u32_dpp v48, v73, v72 row_mirror row_mask:0xf bank_mask:0xf
  s_nop 1
  v_mov_b32_dpp v50, v48 quad_perm:[2,3,0,1] row_mask:0xf bank_mask:0xf
  v_mov_b32_dpp v51, v49 quad_perm:[2,3,0,1] row_mask:0xf bank_mask:0xf
  v_med3_u32 v72, v48, v50, v61
  v_med3_u32 v73, v49, v51, v61
  s_nop 0
  v_mov_b32_dpp v50, v72 quad_perm:[1,0,3,2] row_mask:0xf bank_mask:0xf
  v_mov_b32_dpp v51, v73 quad_perm:[1,0,3,2] row_mask:0xf bank_mask:0xf
  v_med3_u32 v48, v72, v50, v60
  v_med3_u32 v49, v73, v51, v60
  v_max_u32 v72, v48, v49
  v_min_u32 v73, v48, v49
  v_mov_b32 v52, v72
  v_mov_b32 v53, v73
  s_nop 0
  v_permlane16_swap_b32 v72, v52
  v_permlane16_swap_b32 v73, v53
  s_nop 0
  v_max_u32_dpp v49, v52, v73 quad_perm:[3,2,1,0] row_mask:0xf bank_mask:0xf
  v_max_u32_dpp v48, v53, v72 quad_perm:[3,2,1,0] row_mask:0xf bank_mask:0xf
  s_nop 1
  v_mov_b32_dpp v50, v48 quad_perm:[2,3,0,1] row_mask:0xf bank_mask:0xf
  v_mov_b32_dpp v51, v49 quad_perm:[2,3,0,1] row_mask:0xf bank_mask:0xf
  v_med3_u32 v72, v48, v50, v61
  v_med3_u32 v73, v49, v51, v61
  s_nop 0
  v_mov_b32_dpp v50, v72 quad_perm:[1,0,3,2] row_mask:0xf bank_mask:0xf
  v_mov_b32_dpp v51, v73 quad_perm:[1,0,3,2] row_mask:0xf bank_mask:0xf
  v_med3_u32 v48, v72, v50, v60
  v_med3_u32 v49, v73, v51, v60
  v_max_u32 v72, v48, v49
  v_min_u32 v73, v48, v49
  v_mov_b32 v52, v72
  v_mov_b32 v53, v73
  s_nop 0
  v_permlane32_swap_b32 v72, v52
  v_permlane32_swap_b32 v73, v53
  s_nop 0
  v_max_u32_dpp v73, v52, v73 quad_perm:[3,2,1,0] row_mask:0xf bank_mask:0xf
  v_max_u32_dpp v72, v53, v72 quad_perm:[3,2,1,0] row_mask:0xf bank_mask:0xf
  s_nop 1
  v_mov_b32_dpp v56, v72 quad_perm:[0,0,1,1] row_mask:0xf bank_mask:0x5
  v_mov_b32_dpp v57, v73 quad_perm:[0,0,1,1] row_mask:0xf bank_mask:0x5
  v_mov_b32_dpp v56, v72 quad_perm:[2,2,3,3] row_mask:0xf bank_mask:0xa
  v_mov_b32_dpp v57, v73 quad_perm:[2,2,3,3] row_mask:0xf bank_mask:0xa
  v_cndmask_b32 v56, v57, v56, s[24:25]
  v_bfe_u32 v56, v56, 5, 11
  v_mad_i32_i24 v56, v56, s58, v82
  global_load_dword v58, v56, s[4:5]
  s_mov_b64 exec, 0xff
  global_load_dword v58, v56, s[4:5] offset:1024
  s_mov_b64 exec, -1
  v_min_u32 v75, v72, v73
  s_nop 1
  v_min_u32_dpp v75, v75, v75 quad_perm:[1,0,3,2] row_mask:0xf bank_mask:0xf
  s_nop 1
  v_min_u32_dpp v75, v75, v75 quad_perm:[2,3,0,1] row_mask:0xf bank_mask:0xf
  v_cmp_ge_u32 vcc, v74, v75
  s_cbranch_vccnz L_slow
L_seldone:
  v_mov_b32 v78, v73
  v_mov_b32 v76, v72
  s_mov_b64 exec, 15
  global_store_dwordx4 v84, v[76:79], s[18:19]
  global_store_dwordx4 v85, v[76:79], s[18:19] sc1
  ds_write_b64 v87, v[72:73] offset:0
  s_mov_b64 exec, -1
  s_waitcnt lgkmcnt(0)
  s_barrier
  s_branch L_copyT
L_fwd:
  v_lshlrev_b32 v74, 2, v2
  s_mul_i32 s3, s20, 384
  v_min_u32 v73, 2, v3
  v_lshlrev_b32 v73, 7, v73
  s_add_u32 s3, s3, 2357760
  v_add_u32 v73, s3, v73
  s_waitcnt lgkmcnt(0)
  s_lshl_b32 s3, s22, 7
  s_add_u32 s3, s3, 557056
  v_mov_b32 v8, s3
  global_load_dword v10, v8, s[18:19] sc1
  s_movk_i32 s3, -1152
  s_barrier
  ds_read_b32 v72, v74 offset:0
  s_waitcnt lgkmcnt(0)
  s_mul_i32 s3, s22, 9216
  s_mul_i32 s28, s20, 3072
  s_add_u32 s3, s3, s28
  s_add_u32 s3, s3, 29696
  v_and_b32 v8, 31, v1
  v_min_u32 v8, 23, v8
  v_lshlrev_b32 v8, 7, v8
  v_lshrrev_b32 v9, 5, v1
  v_mul_u32_u24 v9, 73728, v9
  v_add3_u32 v8, v8, v9, s3
  global_load_dword v11, v8, s[18:19] sc1
  s_branch L_fin
L_waves:
  s_cmp_ge_u32 s21, 18
  s_cbranch_scc1 L_nonG
  s_mul_i32 s3, s20, 192
  s_sub_u32 s3, s3, 192
  v_lshl_add_u32 v4, v3, 3, s3
  s_mov_b32 s24, 9216
  v_mul_lo_u32 v4, v4, s24
  v_lshlrev_b32 v5, 4, v2
  s_mul_i32 s31, s22, 9
  s_lshr_b32 s3, s21, 1
  s_add_u32 s31, s31, s3
  s_lshl_b32 s3, s31, 7
  v_add3_u32 v4, v4, v5, s3
  s_mov_b32 s25, 525312
  s_bitcmp1_b32 s21, 0
  s_waitcnt lgkmcnt(0)
  s_cselect_b32 s26, s10, s8
  s_cselect_b32 s27, s11, s9
  s_load_dword s23, s[18:19], 0
  s_waitcnt lgkmcnt(0)
  s_lshr_b32 s3, s26, 7
  s_add_u32 s3, s3, s31
  s_and_b32 s33, s3, 7
  s_cmp_eq_u32 s33, 3
  global_load_dwordx4 v[32:35], v4, s[26:27] nt
  v_add_u32 v4, s24, v4
  global_load_dwordx4 v[36:39], v4, s[26:27] nt
  v_add_u32 v4, s24, v4
  global_load_dwordx4 v[40:43], v4, s[26:27] nt
  v_add_u32 v4, s24, v4
  global_load_dwordx4 v[44:47], v4, s[26:27] nt
  v_add_u32 v4, s24, v4
  global_load_dwordx4 v[48:51], v4, s[26:27] nt
  v_add_u32 v4, s24, v4
  s_cbranch_scc1 L_g3w5
L_g3b5:
  global_load_dwordx4 v[52:55], v4, s[26:27] nt
  v_add_u32 v4, s24, v4
  s_cbranch_scc1 L_g3w6
L_g3b6:
  global_load_dwordx4 v[56:59], v4, s[26:27] nt
  v_add_u32 v4, s24, v4
  s_cbranch_scc1 L_g3w7
L_g3b7:
  global_load_dwordx4 v[60:63], v4, s[26:27] nt
  v_add_u32 v4, s25, v4
  s_cbranch_scc1 L_g3w8
L_g3b8:
  global_load_dwordx4 v[64:67], v4, s[26:27] nt
  v_add_u32 v4, s24, v4
  s_mov_b32 s40, 0x05040100
  s_mov_b32 s41, 0x07060302
  s_mul_i32 s3, s20, 3136
  s_sub_u32 s3, s3, 3136
  v_mul_u32_u24 v5, 192, v3
  v_lshlrev_b32 v6, 4, v2
  v_add3_u32 v5, v5, v6, s3
  v_bfe_u32 v21, v0, 1, 1
  v_mul_u32_u24 v21, 1568, v21
  v_bfe_u32 v22, v0, 3, 3
  v_mul_u32_u24 v22, 192, v22
  v_add_u32 v21, v21, v22
  v_bfe_u32 v22, v0, 2, 1
  v_lshrrev_b32 v23, 6, v0
  v_lshl_add_u32 v22, v23, 1, v22
  v_lshl_add_u32 v21, v22, 4, v21
  v_and_b32 v22, 1, v0
  v_lshl_add_u32 v21, v22, 3, v21
  v_add_u32 v21, 64, v21
  s_mul_i32 s3, s22, 9
  s_lshr_b32 s28, s21, 1
  s_add_u32 s3, s3, s28
  s_lshl_b32 s3, s3, 10
  s_and_b32 s31, s21, 1
  s_mul_i32 s28, s31, 73728
  s_add_u32 s3, s3, s28
  s_add_u32 s3, s3, 32768
  v_lshl_add_u32 v20, v0, 2, s3
  v_add_u32 v19, 147456, v20
  s_mov_b32 s28, 0xbfb8aa3b
  s_mov_b32 s29, 0xfffffffe
  v_bfe_u32 v18, v1, 1, 3
  s_lshl_b32 s3, s22, 7
  s_add_u32 s3, s3, 557056
  v_lshl_add_u32 v18, v18, 3, s3
  v_lshrrev_b32 v7, 4, v1
  v_lshlrev_b32 v7, 5, v7
  v_and_b32 v8, 1, v1
  v_lshl_add_u32 v7, v8, 4, v7
  s_mul_i32 s3, s20, 384
  s_add_u32 s3, s3, 2357760
  v_add_u32 v7, s3, v7
  s_movk_i32 s32, -1152
  s_waitcnt lgkmcnt(0)
  s_add_u32 s23, s23, 2654435769
  s_cmp_eq_u32 s33, 3
  s_waitcnt vmcnt(8)
  s_cbranch_scc1 L_g3w9
L_g3b9:
  global_load_dwordx4 v[68:71], v4, s[26:27] nt
  v_add_u32 v4, s24, v4
  s_waitcnt vmcnt(8)
  s_cbranch_scc1 L_g3w10
L_g3b10:
  global_load_dwordx4 v[72:75], v4, s[26:27] nt
  v_add_u32 v4, s24, v4
  v_perm_b32 v128, v36, v32, s40
  v_perm_b32 v132, v36, v32, s41
  v_perm_b32 v136, v37, v33, s40
  v_perm_b32 v140, v37, v33, s41
  v_perm_b32 v144, v38, v34, s40
  v_perm_b32 v148, v38, v34, s41
  v_perm_b32 v152, v39, v35, s40
  v_perm_b32 v156, v39, v35, s41
  s_waitcnt vmcnt(8)
  s_cbranch_scc1 L_g3w11
L_g3b11:
  global_load_dwordx4 v[76:79], v4, s[26:27] nt
  v_add_u32 v4, s24, v4
  s_waitcnt vmcnt(8)
  s_cbranch_scc1 L_g3w12
L_g3b12:
  global_load_dwordx4 v[80:83], v4, s[26:27] nt
  v_add_u32 v4, s24, v4
  v_perm_b32 v129, v44, v40, s40
  v_perm_b32 v133, v44, v40, s41
  v_perm_b32 v137, v45, v41, s40
  v_perm_b32 v141, v45, v41, s41
  v_perm_b32 v145, v46, v42, s40
  v_perm_b32 v149, v46, v42, s41
  v_perm_b32 v153, v47, v43, s40
  v_perm_b32 v157, v47, v43, s41
  s_waitcnt vmcnt(8)
  s_cbranch_scc1 L_g3w13
L_g3b13:
  global_load_dwordx4 v[84:87], v4, s[26:27] nt
  v_add_u32 v4, s24, v4
  s_waitcnt vmcnt(8)
  s_cbranch_scc1 L_g3w14
L_g3b14:
  global_load_dwordx4 v[88:91], v4, s[26:27] nt
  v_add_u32 v4, s24, v4
  v_perm_b32 v130, v52, v48, s40
  v_perm_b32 v134, v52, v48, s41
  v_perm_b32 v138, v53, v49, s40
  v_perm_b32 v142, v53, v49, s41
  v_perm_b32 v146, v54, v50, s40
  v_perm_b32 v150, v54, v50, s41
  v_perm_b32 v154, v55, v51, s40
  v_perm_b32 v158, v55, v51, s41
  s_waitcnt vmcnt(8)
  s_cbranch_scc1 L_g3w15
L_g3b15:
  global_load_dwordx4 v[92:95], v4, s[26:27] nt
  v_add_u32 v4, s25, v4
  s_waitcnt vmcnt(8)
  s_cbranch_scc1 L_g3w16
L_g3b16:
  global_load_dwordx4 v[96:99], v4, s[26:27] nt
  v_add_u32 v4, s24, v4
  v_perm_b32 v131, v60, v56, s40
  v_perm_b32 v135, v60, v56, s41
  v_perm_b32 v139, v61, v57, s40
  v_perm_b32 v143, v61, v57, s41
  v_perm_b32 v147, v62, v58, s40
  v_perm_b32 v151, v62, v58, s41
  v_perm_b32 v155, v63, v59, s40
  v_perm_b32 v159, v63, v59, s41
  s_waitcnt vmcnt(8)
  s_cbranch_scc1 L_g3w17
L_g3b17:
  global_load_dwordx4 v[100:103], v4, s[26:27] nt
  v_add_u32 v4, s24, v4
  s_waitcnt vmcnt(8)
  s_cbranch_scc1 L_g3w18
L_g3b18:
  global_load_dwordx4 v[104:107], v4, s[26:27] nt
  v_add_u32 v4, s24, v4
  v_perm_b32 v32, v68, v64, s40
  v_perm_b32 v36, v68, v64, s41
  v_perm_b32 v40, v69, v65, s40
  v_perm_b32 v44, v69, v65, s41
  v_perm_b32 v48, v70, v66, s40
  v_perm_b32 v52, v70, v66, s41
  v_perm_b32 v56, v71, v67, s40
  v_perm_b32 v60, v71, v67, s41
  s_waitcnt vmcnt(8)
  s_cbranch_scc1 L_g3w19
L_g3b19:
  global_load_dwordx4 v[108:111], v4, s[26:27] nt
  v_add_u32 v4, s24, v4
  s_waitcnt vmcnt(8)
  s_cbranch_scc1 L_g3w20
L_g3b20:
  global_load_dwordx4 v[112:115], v4, s[26:27] nt
  v_add_u32 v4, s24, v4
  v_perm_b32 v33, v76, v72, s40
  v_perm_b32 v37, v76, v72, s41
  v_perm_b32 v41, v77, v73, s40
  v_perm_b32 v45, v77, v73, s41
  v_perm_b32 v49, v78, v74, s40
  v_perm_b32 v53, v78, v74, s41
  v_perm_b32 v57, v79, v75, s40
  v_perm_b32 v61, v79, v75, s41
  s_waitcnt vmcnt(8)
  s_cbranch_scc1 L_g3w21
L_g3b21:
  global_load_dwordx4 v[116:119], v4, s[26:27] nt
  v_add_u32 v4, s24, v4
  s_waitcnt vmcnt(8)
  s_cbranch_scc1 L_g3w22
L_g3b22:
  global_load_dwordx4 v[120:123], v4, s[26:27] nt
  v_add_u32 v4, s24, v4
  v_perm_b32 v34, v84, v80, s40
  v_perm_b32 v38, v84, v80, s41
  v_perm_b32 v42, v85, v81, s40
  v_perm_b32 v46, v85, v81, s41
  v_perm_b32 v50, v86, v82, s40
  v_perm_b32 v54, v86, v82, s41
  v_perm_b32 v58, v87, v83, s40
  v_perm_b32 v62, v87, v83, s41
  s_waitcnt vmcnt(8)
  s_cbranch_scc1 L_g3w23
L_g3b23:
  global_load_dwordx4 v[124:127], v4, s[26:27] nt
  s_waitcnt vmcnt(8)
  v_perm_b32 v35, v92, v88, s40
  v_perm_b32 v39, v92, v88, s41
  v_perm_b32 v43, v93, v89, s40
  v_perm_b32 v47, v93, v89, s41
  v_perm_b32 v51, v94, v90, s40
  v_perm_b32 v55, v94, v90, s41
  v_perm_b32 v59, v95, v91, s40
  v_perm_b32 v63, v95, v91, s41
  s_waitcnt vmcnt(6)
  v_perm_b32 v64, v100, v96, s40
  v_perm_b32 v68, v100, v96, s41
  v_perm_b32 v72, v101, v97, s40
  v_perm_b32 v76, v101, v97, s41
  v_perm_b32 v80, v102, v98, s40
  v_perm_b32 v84, v102, v98, s41
  v_perm_b32 v88, v103, v99, s40
  v_perm_b32 v92, v103, v99, s41
  s_waitcnt vmcnt(4)
  v_perm_b32 v65, v108, v104, s40
  v_perm_b32 v69, v108, v104, s41
  v_perm_b32 v73, v109, v105, s40
  v_perm_b32 v77, v109, v105, s41
  v_perm_b32 v81, v110, v106, s40
  v_perm_b32 v85, v110, v106, s41
  v_perm_b32 v89, v111, v107, s40
  v_perm_b32 v93, v111, v107, s41
  global_load_dwordx2 v[16:17], v18, s[18:19] sc1
  s_waitcnt vmcnt(3)
  v_perm_b32 v66, v116, v112, s40
  v_perm_b32 v70, v116, v112, s41
  v_perm_b32 v74, v117, v113, s40
  v_perm_b32 v78, v117, v113, s41
  v_perm_b32 v82, v118, v114, s40
  v_perm_b32 v86, v118, v114, s41
  v_perm_b32 v90, v119, v115, s40
  v_perm_b32 v94, v119, v115, s41
  s_waitcnt vmcnt(1)
  v_perm_b32 v67, v124, v120, s40
  v_perm_b32 v71, v124, v120, s41
  v_perm_b32 v75, v125, v121, s40
  v_perm_b32 v79, v125, v121, s41
  v_perm_b32 v83, v126, v122, s40
  v_perm_b32 v87, v126, v122, s41
  v_perm_b32 v91, v127, v123, s40
  v_perm_b32 v95, v127, v123, s41
L_Gdone:
L_chkG:
  s_waitcnt vmcnt(0)
  v_cmp_ne_u32 vcc, s23, v17
  v_bfe_u32 v6, v16, 5, 11
  s_cbranch_vccnz L_retryG
  v_mad_i32_i24 v7, v6, s32, v7
  global_load_dwordx4 v[160:163], v7, s[4:5] offset:0
  global_load_dwordx4 v[164:167], v7, s[4:5] offset:128
  global_load_dwordx4 v[168:171], v7, s[4:5] offset:256
  s_waitcnt vmcnt(2)
  v_mfma_f32_16x16x32_bf16 v[184:187], v[160:163], v[128:131], 0
  v_mfma_f32_16x16x32_bf16 v[188:191], v[160:163], v[132:135], 0
  v_mfma_f32_16x16x32_bf16 v[192:195], v[160:163], v[136:139], 0
  v_mfma_f32_16x16x32_bf16 v[196:199], v[160:163], v[140:143], 0
  s_waitcnt vmcnt(1)
  v_mfma_f32_16x16x32_bf16 v[184:187], v[164:167], v[32:35], v[184:187]
  v_mfma_f32_16x16x32_bf16 v[188:191], v[164:167], v[36:39], v[188:191]
  v_mfma_f32_16x16x32_bf16 v[192:195], v[164:167], v[40:43], v[192:195]
  v_mfma_f32_16x16x32_bf16 v[196:199], v[164:167], v[44:47], v[196:199]
  s_waitcnt vmcnt(0)
  v_mfma_f32_16x16x32_bf16 v[184:187], v[168:171], v[64:67], v[184:187]
  v_mfma_f32_16x16x32_bf16 v[188:191], v[168:171], v[68:71], v[188:191]
  v_mfma_f32_16x16x32_bf16 v[192:195], v[168:171], v[72:75], v[192:195]
  v_mfma_f32_16x16x32_bf16 v[196:199], v[168:171], v[76:79], v[196:199]
  v_mfma_f32_16x16x32_bf16 v[200:203], v[160:163], v[144:147], 0
  v_mfma_f32_16x16x32_bf16 v[204:207], v[160:163], v[148:151], 0
  v_mfma_f32_16x16x32_bf16 v[208:211], v[160:163], v[152:155], 0
  v_mfma_f32_16x16x32_bf16 v[212:215], v[160:163], v[156:159], 0
  v_mfma_f32_16x16x32_bf16 v[200:203], v[164:167], v[48:51], v[200:203]
  v_add_f32_dpp v8, v185, v184 row_ror:8 row_mask:0xf bank_mask:0x3
  v_mfma_f32_16x16x32_bf16 v[204:207], v[164:167], v[52:55], v[204:207]
  v_add_f32_dpp v8, v186, v187 row_ror:8 row_mask:0xf bank_mask:0xc
  v_mfma_f32_16x16x32_bf16 v[208:211], v[164:167], v[56:59], v[208:211]
  v_add_f32_dpp v9, v189, v188 row_ror:8 row_mask:0xf bank_mask:0x3
  v_add_f32_dpp v9, v190, v191 row_ror:8 row_mask:0xf bank_mask:0xc
  v_mfma_f32_16x16x32_bf16 v[212:215], v[164:167], v[60:63], v[212:215]
  v_add_f32_dpp v10, v193, v192 row_ror:8 row_mask:0xf bank_mask:0x3
  v_add_f32_dpp v10, v194, v195 row_ror:8 row_mask:0xf bank_mask:0xc
  v_mfma_f32_16x16x32_bf16 v[200:203], v[168:171], v[80:83], v[200:203]
  v_add_f32_dpp v11, v197, v196 row_ror:8 row_mask:0xf bank_mask:0x3
  v_add_f32_dpp v11, v198, v199 row_ror:8 row_mask:0xf bank_mask:0xc
  v_mfma_f32_16x16x32_bf16 v[204:207], v[168:171], v[84:87], v[204:207]
  ds_write_b128 v5, v[8:11] offset:64
  v_mfma_f32_16x16x32_bf16 v[208:211], v[168:171], v[88:91], v[208:211]
  v_mfma_f32_16x16x32_bf16 v[212:215], v[168:171], v[92:95], v[212:215]
  s_nop 4
  v_add_f32_dpp v12, v201, v200 row_ror:8 row_mask:0xf bank_mask:0x3
  v_add_f32_dpp v12, v202, v203 row_ror:8 row_mask:0xf bank_mask:0xc
  v_add_f32_dpp v13, v205, v204 row_ror:8 row_mask:0xf bank_mask:0x3
  v_add_f32_dpp v13, v206, v207 row_ror:8 row_mask:0xf bank_mask:0xc
  v_add_f32_dpp v14, v209, v208 row_ror:8 row_mask:0xf bank_mask:0x3
  v_add_f32_dpp v14, v210, v211 row_ror:8 row_mask:0xf bank_mask:0xc
  v_add_f32_dpp v15, v213, v212 row_ror:8 row_mask:0xf bank_mask:0x3
  v_add_f32_dpp v15, v214, v215 row_ror:8 row_mask:0xf bank_mask:0xc
  ds_write_b128 v5, v[12:15] offset:1632
  s_waitcnt lgkmcnt(0)
L_tailG:
  s_barrier
  ds_read_b64 v[8:9], v21
  ds_read_b64 v[10:11], v21 offset:3136
  ds_read_b64 v[12:13], v21 offset:6272
  s_cmp_eq_u32 s31, 1
  s_waitcnt lgkmcnt(1)
  v_add_f32 v8, v8, v10
  v_add_f32 v9, v9, v11
  s_waitcnt lgkmcnt(0)
  v_add_f32 v8, v8, v12
  v_add_f32 v9, v9, v13
  v_cvt_pk_bf16_f32 v8, v8, v9
  s_cbranch_scc1 L_pubG
  v_lshlrev_b32 v9, 16, v8
  v_and_b32 v8, 0xffff0000, v8
  v_mul_f32 v10, s28, v9
  v_mul_f32 v11, s28, v8
  v_exp_f32 v10, v10
  v_exp_f32 v11, v11
  v_add_f32 v10, 1.0, v10
  v_add_f32 v11, 1.0, v11
  v_rcp_f32 v10, v10
  v_rcp_f32 v11, v11
  v_mul_f32 v10, v9, v10
  v_mul_f32 v11, v8, v11
  v_cvt_pk_bf16_f32 v8, v10, v11
L_pubG:
  v_min_u32 v8, s29, v8
  global_store_dword v20, v8, s[18:19]
  s_waitcnt vmcnt(0)
  global_store_dword v19, v8, s[18:19] sc1
  s_cmp_lg_u32 s20, 0
  s_cbranch_scc1 L_fin
  s_mul_i32 s3, s22, 9216
  s_add_u32 s3, s3, 32768
  v_min_u32 v70, 35, v0
  v_lshlrev_b32 v70, 8, v70
  v_add_u32 v70, s3, v70
  v_add_u32 v69, 73728, v70
  s_mov_b32 s32, 10
L_gt:
  global_load_dword v71, v70, s[18:19] sc1
  global_load_dword v68, v69, s[18:19] sc1
  s_sub_u32 s32, s32, 1
  s_cbranch_scc1 L_gtx
  s_waitcnt vmcnt(0)
  v_max_u32 v71, v71, v68
  v_cmp_eq_u32 vcc, -1, v71
  s_cbranch_vccnz L_gt
L_gtx:
  s_branch L_Fres
L_retryG:
  s_and_b32 s38, s30, 63
  s_cmp_eq_u32 s38, 0
  s_cselect_b32 s38, 4096, 0
  s_add_u32 s38, s18, s38
  s_addc_u32 s39, s19, 0
  global_load_dwordx2 v[16:17], v18, s[38:39] sc1
  s_sub_u32 s30, s30, 1
  s_cbranch_scc0 L_chkG
  s_endpgm
L_Gctl:
  v_bfe_u32 v21, v0, 1, 1
  v_mul_u32_u24 v21, 1568, v21
  v_bfe_u32 v22, v0, 3, 3
  v_mul_u32_u24 v22, 192, v22
  v_add_u32 v21, v21, v22
  v_bfe_u32 v22, v0, 2, 1
  v_lshrrev_b32 v23, 6, v0
  v_lshl_add_u32 v22, v23, 1, v22
  v_lshl_add_u32 v21, v22, 4, v21
  v_and_b32 v22, 1, v0
  v_lshl_add_u32 v21, v22, 3, v21
  v_add_u32 v21, 64, v21
  s_mul_i32 s3, s22, 9
  s_lshr_b32 s28, s21, 1
  s_add_u32 s3, s3, s28
  s_lshl_b32 s3, s3, 10
  s_and_b32 s31, s21, 1
  s_mul_i32 s28, s31, 73728
  s_add_u32 s3, s3, s28
  s_add_u32 s3, s3, 32768
  v_lshl_add_u32 v20, v0, 2, s3
  v_add_u32 v19, 147456, v20
  s_mov_b32 s28, 0xbfb8aa3b
  s_mov_b32 s29, 0xfffffffe
  v_mul_u32_u24 v28, 12, v0
  v_add_u32 v28, v28, v20
  global_store_dwordx4 v28, v[84:87], s[18:19] sc1
  v_add_u32 v28, 147456, v28
  global_store_dwordx4 v28, v[84:87], s[18:19] sc1
  s_waitcnt vmcnt(0)
  s_lshl_b32 s3, s2, 2
  s_add_u32 s3, s3, 573440
  v_mov_b32 v28, s3
  s_mov_b64 exec, 1
  global_store_dword v28, v7, s[18:19] sc1
  s_mov_b64 exec, -1
  s_branch L_tailG
L_g3w5:
  s_waitcnt vmcnt(4)
  s_branch L_g3b5
L_g3w6:
  s_waitcnt vmcnt(4)
  s_branch L_g3b6
L_g3w7:
  s_waitcnt vmcnt(4)
  s_branch L_g3b7
L_g3w8:
  s_waitcnt vmcnt(4)
  s_branch L_g3b8
L_g3w9:
  s_waitcnt vmcnt(4)
  s_branch L_g3b9
L_g3w10:
  s_waitcnt vmcnt(4)
  s_branch L_g3b10
L_g3w11:
  s_waitcnt vmcnt(4)
  s_branch L_g3b11
L_g3w12:
  s_waitcnt vmcnt(4)
  s_branch L_g3b12
L_g3w13:
  s_waitcnt vmcnt(4)
  s_branch L_g3b13
L_g3w14:
  s_waitcnt vmcnt(4)
  s_branch L_g3b14
L_g3w15:
  s_waitcnt vmcnt(4)
  s_branch L_g3b15
L_g3w16:
  s_waitcnt vmcnt(4)
  s_branch L_g3b16
L_g3w17:
  s_waitcnt vmcnt(4)
  s_branch L_g3b17
L_g3w18:
  s_waitcnt vmcnt(4)
  s_branch L_g3b18
L_g3w19:
  s_waitcnt vmcnt(4)
  s_branch L_g3b19
L_g3w20:
  s_waitcnt vmcnt(4)
  s_branch L_g3b20
L_g3w21:
  s_waitcnt vmcnt(4)
  s_branch L_g3b21
L_g3w22:
  s_waitcnt vmcnt(4)
  s_branch L_g3b22
L_g3w23:
  s_waitcnt vmcnt(4)
  s_branch L_g3b23
L_nonG:
  s_cmp_eq_u32 s21, 31
  s_cbranch_scc1 L_fwd
  s_cmp_lt_u32 s21, 27
  s_cbranch_scc1 L_Dw
  s_waitcnt lgkmcnt(0)
  s_sub_u32 s33, s21, 27
  s_mul_i32 s33, s33, 3
  s_add_u32 s33, s33, s20
  s_sub_u32 s33, s33, 1
  s_mov_b32 s24, 9216
  v_mul_lo_u32 v10, v1, s24
  s_mul_i32 s25, s22, 9
  s_bitcmp1_b32 s33, 0
  s_cselect_b32 s52, s10, s8
  s_cselect_b32 s53, s11, s9
  s_lshr_b32 s3, s52, 7
  s_add_u32 s3, s3, s25
  s_sub_u32 s3, 3, s3
  s_and_b32 s26, s3, 7
  s_lshr_b32 s27, s33, 1
  s_cmp_ge_u32 s27, 3
  s_cselect_b32 s28, 1, 0
  s_cselect_b32 s3, 3, 0
  s_sub_u32 s27, s27, s3
  s_cmp_eq_u32 s26, 0
  s_cselect_b32 s29, s28, 0
  s_cselect_b32 s28, 0, s28
  s_lshl_b32 s29, s29, 3
  s_add_u32 s26, s26, s29
  s_mul_i32 s27, s27, 1769472
  s_mul_i32 s34, s28, 589824
  s_add_u32 s3, s26, s25
  s_lshl_b32 s3, s3, 7
  s_add_u32 s3, s3, s27
  s_sub_u32 s3, s3, s34
  s_add_u32 s3, s3, 1179648
  v_add_u32 v16, s3, v10
  v_subrev_u32 v15, 589824, v16
  s_and_b32 s35, s26, 7
  s_cmp_lg_u32 s28, 0
  s_cbranch_scc1 L_e1
  s_cmp_lg_u32 s35, 0
  s_cbranch_scc1 L_e2
  global_load_dword v17, v15, s[52:53]
  s_branch L_e2
L_e1:
  global_load_dword v17, v16, s[52:53]
L_e2:
  s_barrier
  s_cmp_lg_u32 s28, 0
  s_cbranch_scc1 L_e3
  global_load_dword v17, v16, s[52:53]
L_e3:
  s_waitcnt vmcnt(0)
  s_barrier
  s_cmp_ge_u32 s33, 9
  s_cbranch_scc1 L_fin
  s_add_u32 s3, s33, 18
  s_lshl_b32 s3, s3, 3
  s_add_u32 s3, s3, s22
  s_lshl_b32 s3, s3, 3
  v_add_u32 v81, s3, v3
  v_mul_u32_u24 v4, 1152, v81
  v_lshl_add_u32 v4, v2, 4, v4
  v_sub_u32 v81, 2047, v81
  s_lshl_b32 s3, s22, 7
  s_add_u32 s3, s3, 561152
  v_lshl_add_u32 v86, v2, 3, s3
  v_mov_b32 v74, 0
  ds_read_b32 v74, v74 offset:32
  s_waitcnt lgkmcnt(0)
  s_nop 0
  v_readfirstlane_b32 s23, v74
  s_nop 1
L_pollRF:
  global_load_dwordx2 v[72:73], v86, s[18:19] sc1
  s_sub_u32 s30, s30, 1
  s_cbranch_scc1 L_end
  s_waitcnt vmcnt(0)
  v_cmp_ne_u32 vcc, s23, v73
  s_cbranch_vccnz L_pollRF
  v_bfe_u32 v72, v72, 5, 11
  global_load_dwordx4 v[88:91], v4, s[4:5] offset:0
  global_load_dwordx4 v[92:95], v4, s[4:5] offset:128
  global_load_dwordx4 v[96:99], v4, s[4:5] offset:256
  global_load_dwordx4 v[100:103], v4, s[4:5] offset:384
  global_load_dwordx4 v[104:107], v4, s[4:5] offset:512
  global_load_dwordx4 v[108:111], v4, s[4:5] offset:640
  global_load_dwordx4 v[112:115], v4, s[4:5] offset:768
  global_load_dwordx4 v[116:119], v4, s[4:5] offset:896
  global_load_dwordx4 v[120:123], v4, s[4:5] offset:1024
  v_mov_b32 v5, 0
  v_mov_b32 v6, 0
  v_readlane_b32 s44, v72, 0
  v_readlane_b32 s45, v72, 1
  v_readlane_b32 s46, v72, 2
  v_readlane_b32 s47, v72, 3
  v_readlane_b32 s48, v72, 4
  v_readlane_b32 s49, v72, 5
  v_readlane_b32 s50, v72, 6
  v_readlane_b32 s51, v72, 7
  s_mov_b64 s[34:35], -1
  s_nop 0
  v_cmp_ne_u32 vcc, s44, v81
  s_and_b64 s[34:35], s[34:35], vcc
  v_cmp_ne_u32 vcc, s45, v81
  s_and_b64 s[34:35], s[34:35], vcc
  v_cmp_ne_u32 vcc, s46, v81
  s_and_b64 s[34:35], s[34:35], vcc
  v_cmp_ne_u32 vcc, s47, v81
  s_and_b64 s[34:35], s[34:35], vcc
  v_cmp_ne_u32 vcc, s48, v81
  s_and_b64 s[34:35], s[34:35], vcc
  v_cmp_ne_u32 vcc, s49, v81
  s_and_b64 s[34:35], s[34:35], vcc
  v_cmp_ne_u32 vcc, s50, v81
  s_and_b64 s[34:35], s[34:35], vcc
  v_cmp_ne_u32 vcc, s51, v81
  s_and_b64 s[34:35], s[34:35], vcc
  s_waitcnt vmcnt(0)
  v_dot2c_f32_bf16 v5, v88, v6
  v_dot2c_f32_bf16 v5, v89, v6
  v_dot2c_f32_bf16 v5, v90, v6
  v_dot2c_f32_bf16 v5, v91, v6
  v_dot2c_f32_bf16 v5, v92, v6
  v_dot2c_f32_bf16 v5, v93, v6
  v_dot2c_f32_bf16 v5, v94, v6
  v_dot2c_f32_bf16 v5, v95, v6
  v_dot2c_f32_bf16 v5, v96, v6
  v_dot2c_f32_bf16 v5, v97, v6
  v_dot2c_f32_bf16 v5, v98, v6
  v_dot2c_f32_bf16 v5, v99, v6
  v_dot2c_f32_bf16 v5, v100, v6
  v_dot2c_f32_bf16 v5, v101, v6
  v_dot2c_f32_bf16 v5, v102, v6
  v_dot2c_f32_bf16 v5, v103, v6
  v_dot2c_f32_bf16 v5, v104, v6
  v_dot2c_f32_bf16 v5, v105, v6
  v_dot2c_f32_bf16 v5, v106, v6
  v_dot2c_f32_bf16 v5, v107, v6
  v_dot2c_f32_bf16 v5, v108, v6
  v_dot2c_f32_bf16 v5, v109, v6
  v_dot2c_f32_bf16 v5, v110, v6
  v_dot2c_f32_bf16 v5, v111, v6
  v_dot2c_f32_bf16 v5, v112, v6
  v_dot2c_f32_bf16 v5, v113, v6
  v_dot2c_f32_bf16 v5, v114, v6
  v_dot2c_f32_bf16 v5, v115, v6
  v_dot2c_f32_bf16 v5, v116, v6
  v_dot2c_f32_bf16 v5, v117, v6
  v_dot2c_f32_bf16 v5, v118, v6
  v_dot2c_f32_bf16 v5, v119, v6
  v_dot2c_f32_bf16 v5, v120, v6
  v_dot2c_f32_bf16 v5, v121, v6
  v_dot2c_f32_bf16 v5, v122, v6
  v_dot2c_f32_bf16 v5, v123, v6
  s_nop 2
  s_branch L_copy1
L_Dw:
  s_waitcnt lgkmcnt(0)
L_wD:
  s_mul_i32 s3, s20, 192
  s_mul_i32 s24, s22, 576
  s_add_u32 s3, s3, s24
  s_sub_u32 s3, s3, 192
  v_lshl_add_u32 v4, v3, 3, s3
  v_mul_u32_u24 v4, 1152, v4
  v_lshlrev_b32 v5, 4, v2
  s_sub_u32 s3, s21, 18
  s_lshl_b32 s3, s3, 7
  v_add3_u32 v4, v4, v5, s3
  global_load_dwordx4 v[32:35], v4, s[12:13] offset:0 nt
  global_load_dwordx4 v[36:39], v4, s[12:13] offset:1152 nt
  s_mov_b32 s40, 0x05040100
  s_mov_b32 s41, 0x07060302
  v_mov_b32 v18, 0
  s_lshl_b32 s3, s22, 2
  s_add_u32 s3, s3, 573440
  v_min_u32 v16, 17, v1
  v_lshl_add_u32 v16, v16, 5, s3
  s_mul_i32 s3, s20, 3328
  s_sub_u32 s3, s3, 3328
  v_mul_u32_u24 v5, 192, v3
  v_lshlrev_b32 v6, 4, v2
  v_add3_u32 v5, v5, v6, s3
  v_bfe_u32 v21, v0, 1, 1
  v_mul_u32_u24 v21, 1664, v21
  v_lshrrev_b32 v22, 5, v0
  v_mul_u32_u24 v23, 192, v22
  v_add_u32 v21, v21, v23
  v_bfe_u32 v23, v0, 2, 3
  v_lshl_add_u32 v21, v23, 4, v21
  v_and_b32 v23, 1, v0
  v_lshl_add_u32 v21, v23, 3, v21
  v_add_u32 v21, 64, v21
  s_sub_u32 s3, s21, 18
  s_lshl_b32 s3, s3, 11
  s_lshl_b32 s28, s22, 8
  s_add_u32 s3, s3, s28
  s_add_u32 s3, s3, 327680
  v_mul_u32_u24 v22, 18432, v22
  v_and_b32 v23, 31, v0
  v_lshlrev_b32 v23, 3, v23
  v_add3_u32 v20, v22, v23, s3
  s_mov_b32 s29, 0xfffffffe
  v_mov_b32 v28, 0
  s_mul_i32 s3, s22, 9216
  s_mul_i32 s28, s20, 3072
  s_add_u32 s3, s3, s28
  s_add_u32 s3, s3, 29696
  v_lshl_add_u32 v7, v1, 4, s3
  v_add_u32 v6, 73728, v7
  s_mov_b32 s28, 0xffff0000
  s_waitcnt vmcnt(1)
  global_load_dwordx4 v[40:43], v4, s[12:13] offset:2304 nt
  s_waitcnt vmcnt(1)
  global_load_dwordx4 v[44:47], v4, s[12:13] offset:3456 nt
  v_add_u32 v4, 4608, v4
  v_perm_b32 v128, v36, v32, s40
  v_perm_b32 v132, v36, v32, s41
  v_perm_b32 v136, v37, v33, s40
  v_perm_b32 v140, v37, v33, s41
  v_perm_b32 v144, v38, v34, s40
  v_perm_b32 v148, v38, v34, s41
  v_perm_b32 v152, v39, v35, s40
  v_perm_b32 v156, v39, v35, s41
  s_waitcnt vmcnt(1)
  global_load_dwordx4 v[48:51], v4, s[12:13] offset:0 nt
  global_load_dwordx4 v[52:55], v4, s[12:13] offset:1152 nt
  global_load_dwordx4 v[56:59], v4, s[12:13] offset:2304 nt
  global_load_dwordx4 v[60:63], v4, s[12:13] offset:3456 nt
  v_add_u32 v4, 69120, v4
  global_load_dwordx4 v[64:67], v4, s[12:13] offset:0 nt
  global_load_dwordx4 v[68:71], v4, s[12:13] offset:1152 nt
  global_load_dwordx4 v[72:75], v4, s[12:13] offset:2304 nt
  global_load_dwordx4 v[76:79], v4, s[12:13] offset:3456 nt
  v_add_u32 v4, 4608, v4
  global_load_dwordx4 v[80:83], v4, s[12:13] offset:0 nt
  s_waitcnt vmcnt(9)
  global_load_dwordx4 v[84:87], v4, s[12:13] offset:1152 nt
  v_perm_b32 v129, v44, v40, s40
  v_perm_b32 v133, v44, v40, s41
  v_perm_b32 v137, v45, v41, s40
  v_perm_b32 v141, v45, v41, s41
  v_perm_b32 v145, v46, v42, s40
  v_perm_b32 v149, v46, v42, s41
  v_perm_b32 v153, v47, v43, s40
  v_perm_b32 v157, v47, v43, s41
  s_waitcnt vmcnt(9)
  global_load_dwordx4 v[88:91], v4, s[12:13] offset:2304 nt
  s_waitcnt vmcnt(9)
  global_load_dwordx4 v[92:95], v4, s[12:13] offset:3456 nt
  v_add_u32 v4, 69120, v4
  v_perm_b32 v130, v52, v48, s40
  v_perm_b32 v134, v52, v48, s41
  v_perm_b32 v138, v53, v49, s40
  v_perm_b32 v142, v53, v49, s41
  v_perm_b32 v146, v54, v50, s40
  v_perm_b32 v150, v54, v50, s41
  v_perm_b32 v154, v55, v51, s40
  v_perm_b32 v158, v55, v51, s41
  s_waitcnt vmcnt(9)
  global_load_dwordx4 v[96:99], v4, s[12:13] offset:0 nt
  s_waitcnt vmcnt(9)
  global_load_dwordx4 v[100:103], v4, s[12:13] offset:1152 nt
  v_perm_b32 v131, v60, v56, s40
  v_perm_b32 v135, v60, v56, s41
  v_perm_b32 v139, v61, v57, s40
  v_perm_b32 v143, v61, v57, s41
  v_perm_b32 v147, v62, v58, s40
  v_perm_b32 v151, v62, v58, s41
  v_perm_b32 v155, v63, v59, s40
  v_perm_b32 v159, v63, v59, s41
  s_waitcnt vmcnt(9)
  global_load_dwordx4 v[104:107], v4, s[12:13] offset:2304 nt
  s_waitcnt vmcnt(9)
  global_load_dwordx4 v[108:111], v4, s[12:13] offset:3456 nt
  v_add_u32 v4, 4608, v4
  v_perm_b32 v32, v68, v64, s40
  v_perm_b32 v36, v68, v64, s41
  v_perm_b32 v40, v69, v65, s40
  v_perm_b32 v44, v69, v65, s41
  v_perm_b32 v48, v70, v66, s40
  v_perm_b32 v52, v70, v66, s41
  v_perm_b32 v56, v71, v67, s40
  v_perm_b32 v60, v71, v67, s41
  s_waitcnt vmcnt(9)
  global_load_dwordx4 v[112:115], v4, s[12:13] offset:0 nt
  s_waitcnt vmcnt(9)
  global_load_dwordx4 v[116:119], v4, s[12:13] offset:1152 nt
  v_perm_b32 v33, v76, v72, s40
  v_perm_b32 v37, v76, v72, s41
  v_perm_b32 v41, v77, v73, s40
  v_perm_b32 v45, v77, v73, s41
  v_perm_b32 v49, v78, v74, s40
  v_perm_b32 v53, v78, v74, s41
  v_perm_b32 v57, v79, v75, s40
  v_perm_b32 v61, v79, v75, s41
  s_waitcnt vmcnt(9)
  global_load_dwordx4 v[120:123], v4, s[12:13] offset:2304 nt
  s_waitcnt vmcnt(9)
  global_load_dwordx4 v[124:127], v4, s[12:13] offset:3456 nt
  v_perm_b32 v34, v84, v80, s40
  v_perm_b32 v38, v84, v80, s41
  v_perm_b32 v42, v85, v81, s40
  v_perm_b32 v46, v85, v81, s41
  v_perm_b32 v50, v86, v82, s40
  v_perm_b32 v54, v86, v82, s41
  v_perm_b32 v58, v87, v83, s40
  v_perm_b32 v62, v87, v83, s41
  s_waitcnt vmcnt(8)
  v_perm_b32 v35, v92, v88, s40
  v_perm_b32 v39, v92, v88, s41
  v_perm_b32 v43, v93, v89, s40
  v_perm_b32 v47, v93, v89, s41
  v_perm_b32 v51, v94, v90, s40
  v_perm_b32 v55, v94, v90, s41
  v_perm_b32 v59, v95, v91, s40
  v_perm_b32 v63, v95, v91, s41
  s_waitcnt vmcnt(6)
  v_perm_b32 v64, v100, v96, s40
  v_perm_b32 v68, v100, v96, s41
  v_perm_b32 v72, v101, v97, s40
  v_perm_b32 v76, v101, v97, s41
  v_perm_b32 v80, v102, v98, s40
  v_perm_b32 v84, v102, v98, s41
  v_perm_b32 v88, v103, v99, s40
  v_perm_b32 v92, v103, v99, s41
  s_waitcnt vmcnt(4)
  v_perm_b32 v65, v108, v104, s40
  v_perm_b32 v69, v108, v104, s41
  v_perm_b32 v73, v109, v105, s40
  v_perm_b32 v77, v109, v105, s41
  v_perm_b32 v81, v110, v106, s40
  v_perm_b32 v85, v110, v106, s41
  v_perm_b32 v89, v111, v107, s40
  v_perm_b32 v93, v111, v107, s41
  global_load_dword v17, v16, s[18:19] sc1
  s_waitcnt vmcnt(3)
  v_perm_b32 v66, v116, v112, s40
  v_perm_b32 v70, v116, v112, s41
  v_perm_b32 v74, v117, v113, s40
  v_perm_b32 v78, v117, v113, s41
  v_perm_b32 v82, v118, v114, s40
  v_perm_b32 v86, v118, v114, s41
  v_perm_b32 v90, v119, v115, s40
  v_perm_b32 v94, v119, v115, s41
  s_waitcnt vmcnt(1)
  v_perm_b32 v67, v124, v120, s40
  v_perm_b32 v71, v124, v120, s41
  v_perm_b32 v75, v125, v121, s40
  v_perm_b32 v79, v125, v121, s41
  v_perm_b32 v83, v126, v122, s40
  v_perm_b32 v87, v126, v122, s41
  v_perm_b32 v91, v127, v123, s40
  v_perm_b32 v95, v127, v123, s41
  s_barrier
  ds_read_b32 v18, v18 offset:32
L_chkR:
  s_waitcnt vmcnt(0) lgkmcnt(0)
  v_cmp_ne_u32 vcc, v18, v17
  s_cbranch_vccnz L_retryR
L_poll2:
  s_and_b32 s38, s30, 63
  s_cmp_eq_u32 s38, 0
  s_cselect_b32 s38, 147456, 0
  s_add_u32 s38, s18, s38
  s_addc_u32 s39, s19, 0
  global_load_dwordx4 v[160:163], v7, s[38:39] offset:0 sc1
  global_load_dwordx4 v[172:175], v6, s[38:39] offset:0 sc1
  global_load_dwordx4 v[164:167], v7, s[38:39] offset:1024 sc1
  global_load_dwordx4 v[176:179], v6, s[38:39] offset:1024 sc1
  global_load_dwordx4 v[168:171], v7, s[38:39] offset:2048 sc1
  global_load_dwordx4 v[180:183], v6, s[38:39] offset:2048 sc1
  s_sub_u32 s30, s30, 1
  s_cbranch_scc1 L_end
L_poll2w:
  s_waitcnt vmcnt(0)
  v_max3_u32 v8, v163, v167, v171
  v_max3_u32 v9, v175, v179, v183
  v_max_u32 v8, v8, v9
  v_cmp_eq_u32 vcc, -1, v8
  s_cbranch_vccnz L_poll2
  v_max3_u32 v16, v160, v161, v162
  v_lshlrev_b32 v8, 16, v160
  v_lshlrev_b32 v9, 16, v172
  v_and_b32 v10, s28, v160
  v_and_b32 v11, s28, v172
  v_mul_f32 v8, v8, v9
  v_mul_f32 v10, v10, v11
  v_cvt_pk_bf16_f32 v160, v8, v10
  v_lshlrev_b32 v12, 16, v161
  v_lshlrev_b32 v13, 16, v173
  v_and_b32 v14, s28, v161
  v_and_b32 v15, s28, v173
  v_mul_f32 v12, v12, v13
  v_mul_f32 v14, v14, v15
  v_cvt_pk_bf16_f32 v161, v12, v14
  v_lshlrev_b32 v8, 16, v162
  v_lshlrev_b32 v9, 16, v174
  v_and_b32 v10, s28, v162
  v_and_b32 v11, s28, v174
  v_mul_f32 v8, v8, v9
  v_mul_f32 v10, v10, v11
  v_cvt_pk_bf16_f32 v162, v8, v10
  v_lshlrev_b32 v12, 16, v163
  v_lshlrev_b32 v13, 16, v175
  v_and_b32 v14, s28, v163
  v_and_b32 v15, s28, v175
  v_mul_f32 v12, v12, v13
  v_mul_f32 v14, v14, v15
  v_cvt_pk_bf16_f32 v163, v12, v14
  s_nop 1
  v_mfma_f32_16x16x32_bf16 v[184:187], v[160:163], v[128:131], 0
  v_max3_u32 v16, v16, v164, v165
  v_max_u32 v16, v16, v166
  v_lshlrev_b32 v8, 16, v164
  v_lshlrev_b32 v9, 16, v176
  v_and_b32 v10, s28, v164
  v_mfma_f32_16x16x32_bf16 v[188:191], v[160:163], v[132:135], 0
  v_and_b32 v11, s28, v176
  v_mul_f32 v8, v8, v9
  v_mul_f32 v10, v10, v11
  v_cvt_pk_bf16_f32 v164, v8, v10
  v_lshlrev_b32 v12, 16, v165
  v_mfma_f32_16x16x32_bf16 v[192:195], v[160:163], v[136:139], 0
  v_lshlrev_b32 v13, 16, v177
  v_and_b32 v14, s28, v165
  v_and_b32 v15, s28, v177
  v_mul_f32 v12, v12, v13
  v_mfma_f32_16x16x32_bf16 v[196:199], v[160:163], v[140:143], 0
  v_mul_f32 v14, v14, v15
  v_cvt_pk_bf16_f32 v165, v12, v14
  v_lshlrev_b32 v8, 16, v166
  v_lshlrev_b32 v9, 16, v178
  v_mfma_f32_16x16x32_bf16 v[200:203], v[160:163], v[144:147], 0
  v_and_b32 v10, s28, v166
  v_and_b32 v11, s28, v178
  v_mul_f32 v8, v8, v9
  v_mul_f32 v10, v10, v11
  v_mfma_f32_16x16x32_bf16 v[204:207], v[160:163], v[148:151], 0
  v_cvt_pk_bf16_f32 v166, v8, v10
  v_lshlrev_b32 v12, 16, v167
  v_lshlrev_b32 v13, 16, v179
  v_and_b32 v14, s28, v167
  v_mfma_f32_16x16x32_bf16 v[208:211], v[160:163], v[152:155], 0
  v_and_b32 v15, s28, v179
  v_mul_f32 v12, v12, v13
  v_mul_f32 v14, v14, v15
  v_cvt_pk_bf16_f32 v167, v12, v14
  v_mfma_f32_16x16x32_bf16 v[212:215], v[160:163], v[156:159], 0
  s_nop 0
  v_mfma_f32_16x16x32_bf16 v[184:187], v[164:167], v[32:35], v[184:187]
  v_max3_u32 v16, v16, v168, v169
  v_max_u32 v16, v16, v170
  v_lshlrev_b32 v8, 16, v168
  v_lshlrev_b32 v9, 16, v180
  v_and_b32 v10, s28, v168
  v_mfma_f32_16x16x32_bf16 v[188:191], v[164:167], v[36:39], v[188:191]
  v_and_b32 v11, s28, v180
  v_mul_f32 v8, v8, v9
  v_mul_f32 v10, v10, v11
  v_cvt_pk_bf16_f32 v168, v8, v10
  v_lshlrev_b32 v12, 16, v169
  v_mfma_f32_16x16x32_bf16 v[192:195], v[164:167], v[40:43], v[192:195]
  v_lshlrev_b32 v13, 16, v181
  v_and_b32 v14, s28, v169
  v_and_b32 v15, s28, v181
  v_mul_f32 v12, v12, v13
  v_mfma_f32_16x16x32_bf16 v[196:199], v[164:167], v[44:47], v[196:199]
  v_mul_f32 v14, v14, v15
  v_cvt_pk_bf16_f32 v169, v12, v14
  v_lshlrev_b32 v8, 16, v170
  v_lshlrev_b32 v9, 16, v182
  v_mfma_f32_16x16x32_bf16 v[200:203], v[164:167], v[48:51], v[200:203]
  v_and_b32 v10, s28, v170
  v_and_b32 v11, s28, v182
  v_mul_f32 v8, v8, v9
  v_mul_f32 v10, v10, v11
  v_mfma_f32_16x16x32_bf16 v[204:207], v[164:167], v[52:55], v[204:207]
  v_cvt_pk_bf16_f32 v170, v8, v10
  v_lshlrev_b32 v12, 16, v171
  v_lshlrev_b32 v13, 16, v183
  v_and_b32 v14, s28, v171
  v_mfma_f32_16x16x32_bf16 v[208:211], v[164:167], v[56:59], v[208:211]
  v_and_b32 v15, s28, v183
  v_mul_f32 v12, v12, v13
  v_mul_f32 v14, v14, v15
  v_cvt_pk_bf16_f32 v171, v12, v14
  v_mfma_f32_16x16x32_bf16 v[212:215], v[164:167], v[60:63], v[212:215]
  s_nop 0
  v_mfma_f32_16x16x32_bf16 v[184:187], v[168:171], v[64:67], v[184:187]
  v_max3_u32 v17, v172, v173, v174
  v_max3_u32 v16, v16, v176, v177
  v_mfma_f32_16x16x32_bf16 v[188:191], v[168:171], v[68:71], v[188:191]
  v_max3_u32 v17, v17, v178, v180
  v_max3_u32 v16, v16, v181, v182
  v_mfma_f32_16x16x32_bf16 v[192:195], v[168:171], v[72:75], v[192:195]
  v_max_u32 v16, v16, v17
  v_cmp_eq_u32 vcc, -1, v16
  v_mfma_f32_16x16x32_bf16 v[196:199], v[168:171], v[76:79], v[196:199]
  s_cbranch_vccnz L_poll2
  v_mfma_f32_16x16x32_bf16 v[200:203], v[168:171], v[80:83], v[200:203]
  v_mfma_f32_16x16x32_bf16 v[204:207], v[168:171], v[84:87], v[204:207]
  s_nop 2
  v_add_f32_dpp v8, v185, v184 row_ror:8 row_mask:0xf bank_mask:0x3
  v_add_f32_dpp v8, v186, v187 row_ror:8 row_mask:0xf bank_mask:0xc
  v_mfma_f32_16x16x32_bf16 v[208:211], v[168:171], v[88:91], v[208:211]
  v_add_f32_dpp v9, v189, v188 row_ror:8 row_mask:0xf bank_mask:0x3
  v_add_f32_dpp v9, v190, v191 row_ror:8 row_mask:0xf bank_mask:0xc
  v_mfma_f32_16x16x32_bf16 v[212:215], v[168:171], v[92:95], v[212:215]
  v_add_f32_dpp v10, v193, v192 row_ror:8 row_mask:0xf bank_mask:0x3
  v_add_f32_dpp v10, v194, v195 row_ror:8 row_mask:0xf bank_mask:0xc
  v_add_f32_dpp v11, v197, v196 row_ror:8 row_mask:0xf bank_mask:0x3
  v_add_f32_dpp v11, v198, v199 row_ror:8 row_mask:0xf bank_mask:0xc
  ds_write_b128 v5, v[8:11] offset:64
  v_add_f32_dpp v12, v201, v200 row_ror:8 row_mask:0xf bank_mask:0x3
  v_add_f32_dpp v12, v202, v203 row_ror:8 row_mask:0xf bank_mask:0xc
  v_add_f32_dpp v13, v205, v204 row_ror:8 row_mask:0xf bank_mask:0x3
  v_add_f32_dpp v13, v206, v207 row_ror:8 row_mask:0xf bank_mask:0xc
  v_add_f32_dpp v14, v209, v208 row_ror:8 row_mask:0xf bank_mask:0x3
  v_add_f32_dpp v14, v210, v211 row_ror:8 row_mask:0xf bank_mask:0xc
  v_add_f32_dpp v15, v213, v212 row_ror:8 row_mask:0xf bank_mask:0x3
  v_add_f32_dpp v15, v214, v215 row_ror:8 row_mask:0xf bank_mask:0xc
  ds_write_b128 v5, v[12:15] offset:1728
  s_waitcnt lgkmcnt(0)
L_tailD:
  s_barrier
  ds_read_b64 v[8:9], v21
  ds_read_b64 v[10:11], v21 offset:3328
  ds_read_b64 v[12:13], v21 offset:6656
  s_waitcnt lgkmcnt(1)
  v_add_f32 v8, v8, v10
  v_add_f32 v9, v9, v11
  s_waitcnt lgkmcnt(0)
  v_add_f32 v8, v8, v12
  v_add_f32 v9, v9, v13
  v_min_u32 v8, s29, v8
  v_min_u32 v9, s29, v9
  global_store_dwordx2 v20, v[8:9], s[18:19] sc1
  s_cmp_lg_u32 s20, 0
  s_cbranch_scc1 L_fin
  s_cmp_lg_u32 s59, 0
  s_cbranch_scc1 L_rdy3
L_rdy3x:
  s_waitcnt vmcnt(0)
  global_load_dwordx2 v[44:45], v24, s[18:19] offset:0 sc1
  global_load_dwordx2 v[46:47], v24, s[18:19] offset:512 sc1
  global_load_dwordx2 v[48:49], v24, s[18:19] offset:1024 sc1
  global_load_dwordx2 v[50:51], v24, s[18:19] offset:1536 sc1
  global_load_dwordx2 v[52:53], v24, s[18:19] offset:0 sc1
  global_load_dwordx2 v[54:55], v24, s[18:19] offset:512 sc1
  global_load_dwordx2 v[56:57], v24, s[18:19] offset:1024 sc1
  global_load_dwordx2 v[58:59], v24, s[18:19] offset:1536 sc1
  s_waitcnt vmcnt(4)
  v_max3_u32 v16, v44, v45, v46
  v_max3_u32 v17, v47, v48, v49
  v_max3_u32 v16, v16, v50, v51
  v_max_u32 v16, v16, v17
  v_cmp_eq_u32 vcc, -1, v16
  s_cbranch_vccnz L_p3more
L_p3A:
  v_add_f32 v8, v44, v46
  v_add_f32 v9, v45, v47
  v_add_f32 v12, v48, v50
  v_add_f32 v13, v49, v51
L_poll3_join:
  v_add_f32 v8, v8, v12
  v_add_f32 v9, v9, v13
  v_lshlrev_b32 v26, 16, v26
  v_fma_f32 v26, v26, 0, v26
  v_permlane32_swap_b32 v8, v9
  s_nop 1
  v_add_f32 v8, v8, v9
  v_cvt_pk_bf16_f32 v8, v8, v8
  v_and_b32 v8, 0xffff0000, v8
  v_mul_f32 v8, v8, v27
  v_cvt_pk_bf16_f32 v8, v8, v8
  v_and_b32 v8, 0xffff0000, v8
  v_add_f32 v8, v8, v26
  v_cvt_pk_bf16_f32 v8, v8, v8
  global_store_short v25, v8, s[14:15]
  s_cmp_lg_u32 s2, 144
  s_cbranch_scc1 L_fin
  v_mov_b32 v9, 0
  s_mov_b64 exec, 1
  global_store_dword v9, v18, s[18:19] offset:0
  s_mov_b64 exec, -1
  s_branch L_fin
L_p3more:
  global_load_dwordx2 v[60:61], v24, s[18:19] offset:0 sc1
  global_load_dwordx2 v[62:63], v24, s[18:19] offset:512 sc1
  global_load_dwordx2 v[64:65], v24, s[18:19] offset:1024 sc1
  global_load_dwordx2 v[66:67], v24, s[18:19] offset:1536 sc1
  global_load_dwordx2 v[44:45], v24, s[18:19] offset:0 sc1
  global_load_dwordx2 v[46:47], v24, s[18:19] offset:512 sc1
  global_load_dwordx2 v[48:49], v24, s[18:19] offset:1024 sc1
  global_load_dwordx2 v[50:51], v24, s[18:19] offset:1536 sc1
L_poll3:
  s_sub_u32 s30, s30, 1
  s_cbranch_scc1 L_end
  s_waitcnt vmcnt(8)
  v_max3_u32 v16, v52, v53, v54
  v_max3_u32 v17, v55, v56, v57
  v_max3_u32 v16, v16, v58, v59
  v_max_u32 v16, v16, v17
  v_cmp_eq_u32 vcc, -1, v16
  s_cbranch_vccz L_p3ok1
  global_load_dwordx2 v[52:53], v24, s[18:19] offset:0 sc1
  global_load_dwordx2 v[54:55], v24, s[18:19] offset:512 sc1
  global_load_dwordx2 v[56:57], v24, s[18:19] offset:1024 sc1
  global_load_dwordx2 v[58:59], v24, s[18:19] offset:1536 sc1
  s_waitcnt vmcnt(8)
  v_max3_u32 v16, v60, v61, v62
  v_max3_u32 v17, v63, v64, v65
  v_max3_u32 v16, v16, v66, v67
  v_max_u32 v16, v16, v17
  v_cmp_eq_u32 vcc, -1, v16
  s_cbranch_vccz L_p3ok2
  global_load_dwordx2 v[60:61], v24, s[18:19] offset:0 sc1
  global_load_dwordx2 v[62:63], v24, s[18:19] offset:512 sc1
  global_load_dwordx2 v[64:65], v24, s[18:19] offset:1024 sc1
  global_load_dwordx2 v[66:67], v24, s[18:19] offset:1536 sc1
  s_waitcnt vmcnt(8)
  v_max3_u32 v16, v44, v45, v46
  v_max3_u32 v17, v47, v48, v49
  v_max3_u32 v16, v16, v50, v51
  v_max_u32 v16, v16, v17
  v_cmp_eq_u32 vcc, -1, v16
  s_cbranch_vccz L_p3A
  global_load_dwordx2 v[44:45], v24, s[18:19] offset:0 sc1
  global_load_dwordx2 v[46:47], v24, s[18:19] offset:512 sc1
  global_load_dwordx2 v[48:49], v24, s[18:19] offset:1024 sc1
  global_load_dwordx2 v[50:51], v24, s[18:19] offset:1536 sc1
  s_branch L_poll3
L_p3ok1:
  v_add_f32 v8, v52, v54
  v_add_f32 v9, v53, v55
  v_add_f32 v12, v56, v58
  v_add_f32 v13, v57, v59
  s_branch L_poll3_join
L_p3ok2:
  v_add_f32 v8, v60, v62
  v_add_f32 v9, v61, v63
  v_add_f32 v12, v64, v66
  v_add_f32 v13, v65, v67
  s_branch L_poll3_join
L_rdy3:
  global_load_dword v30, v28, s[18:19] sc1
  s_sub_u32 s30, s30, 1
  s_cbranch_scc1 L_end
  s_waitcnt vmcnt(0)
  v_cmp_ne_u32 vcc, s23, v30
  s_cbranch_vccnz L_rdy3
  s_branch L_rdy3x
L_retryR:
  global_load_dword v17, v16, s[18:19] sc1
  s_sub_u32 s30, s30, 1
  s_cbranch_scc0 L_chkR
  s_endpgm
L_Dctl:
  v_mov_b32 v18, 0
  ds_write_b32 v18, v7 offset:32
  v_bfe_u32 v21, v0, 1, 1
  v_mul_u32_u24 v21, 1664, v21
  v_lshrrev_b32 v22, 5, v0
  v_mul_u32_u24 v23, 192, v22
  v_add_u32 v21, v21, v23
  v_bfe_u32 v23, v0, 2, 3
  v_lshl_add_u32 v21, v23, 4, v21
  v_and_b32 v23, 1, v0
  v_lshl_add_u32 v21, v23, 3, v21
  v_add_u32 v21, 64, v21
  s_sub_u32 s3, s21, 18
  s_lshl_b32 s3, s3, 11
  s_lshl_b32 s28, s22, 8
  s_add_u32 s3, s3, s28
  s_add_u32 s3, s3, 327680
  v_mul_u32_u24 v22, 18432, v22
  v_and_b32 v23, 31, v0
  v_lshlrev_b32 v23, 3, v23
  v_add3_u32 v20, v22, v23, s3
  s_mov_b32 s29, 0xfffffffe
  s_lshl_b32 s3, s22, 7
  s_add_u32 s3, s3, 557056
  v_lshl_add_u32 v29, v2, 3, s3
  s_mul_i32 s3, s22, 9
  s_add_u32 s3, s3, s21
  s_sub_u32 s3, s3, 18
  s_lshl_b32 s3, s3, 11
  s_add_u32 s3, s3, 327680
  v_lshl_add_u32 v24, v0, 3, s3
  s_sub_u32 s3, s21, 18
  s_lshl_b32 s3, s3, 11
  s_lshl_b32 s28, s22, 8
  s_add_u32 s3, s3, s28
  s_add_u32 s3, s3, 327680
  v_lshrrev_b32 v28, 4, v0
  v_mul_u32_u24 v28, 18432, v28
  v_and_b32 v30, 15, v0
  v_lshlrev_b32 v30, 4, v30
  v_add3_u32 v28, v28, v30, s3
  v_add_u32 v30, 73728, v28
  global_store_dwordx4 v28, v[84:87], s[18:19] sc1
  global_store_dwordx4 v30, v[84:87], s[18:19] sc1
  s_lshl_b32 s3, s21, 7
  s_add_u32 s3, s3, 573184
  v_lshl_add_u32 v31, v2, 2, s3
  s_lshl_b32 s28, s22, 2
  s_add_u32 s3, s3, s28
  v_mov_b32 v28, s3
  s_waitcnt vmcnt(0)
  s_mov_b64 exec, 1
  global_store_dword v28, v7, s[18:19] sc1
  s_mov_b64 exec, -1
  s_waitcnt vmcnt(0)
  global_load_dword v30, v31, s[18:19] sc1
  v_mov_b32 v28, v31
  s_waitcnt vmcnt(0)
  v_cmp_ne_u32 vcc, s23, v30
  s_bcnt1_i32_b64 s59, vcc
  v_and_b32 v25, 31, v0
  v_lshlrev_b32 v25, 2, v25
  v_lshrrev_b32 v26, 5, v0
  v_lshl_add_u32 v25, v26, 1, v25
  s_sub_u32 s3, s21, 18
  s_lshl_b32 s3, s3, 7
  s_add_u32 s3, s3, 2358144
  v_add_u32 v25, s3, v25
  v_mov_b32 v18, s23
  s_waitcnt lgkmcnt(0)
  s_barrier
L_pollRD:
  s_and_b32 s38, s30, 63
  s_cmp_eq_u32 s38, 0
  s_cselect_b32 s38, 4096, 0
  s_add_u32 s38, s18, s38
  s_addc_u32 s39, s19, 0
  global_load_dwordx2 v[78:79], v29, s[38:39] sc1
  s_sub_u32 s30, s30, 1
  s_cbranch_scc1 L_end
  s_waitcnt vmcnt(0)
  v_cmp_ne_u32 vcc, s23, v79
  s_cbranch_vccnz L_pollRD
L_RDok:
  v_readlane_b32 s31, v78, s22
  v_min_u32_dpp v77, v78, v78 quad_perm:[1,0,3,2] row_mask:0xf bank_mask:0xf
  s_movk_i32 s3, -1152
  v_mov_b32 v44, s31
  v_min_u32_dpp v77, v77, v77 quad_perm:[2,3,0,1] row_mask:0xf bank_mask:0xf
  v_bfe_u32 v26, v44, 5, 11
  v_mad_i32_i24 v25, v26, s3, v25
  v_min_u32_dpp v77, v77, v77 row_half_mirror row_mask:0xf bank_mask:0xf
  global_load_ushort v26, v25, s[4:5]
  v_ashrrev_i32 v27, 31, v44
  v_not_b32 v27, v27
  v_or_b32 v27, 0x80000000, v27
  v_xor_b32 v27, v27, v44
  v_and_b32 v27, 0xffff0000, v27
  v_mul_f32 v27, 0xbfb8aa3b, v27
  v_exp_f32 v27, v27
  s_nop 0
  v_add_f32 v27, 1.0, v27
  v_rcp_f32 v27, v27
  s_nop 0
  v_cvt_pk_bf16_f32 v27, v27, v27
  v_and_b32 v27, 0xffff0000, v27
  v_cmp_lt_u32 s[34:35], v6, v77
  s_branch L_tailD
L_slow:
  s_waitcnt vmcnt(0)
  v_mov_b32 v140, 0
  v_mov_b32 v141, 0
  s_mov_b32 s59, 0
  v_and_b32 v47, 3, v0
  v_lshlrev_b32 v47, 1, v47
  v_add_u32 v46, 1, v47
  v_mov_b32 v198, v46
  v_mov_b32 v199, v47
L_slow_a:
  v_mov_b32 v144, v124
  v_mov_b32 v145, v125
  v_mov_b32 v146, v126
  v_mov_b32 v147, v128
  v_mov_b32 v148, v129
  v_mov_b32 v149, v130
  v_mov_b32 v150, v132
  v_mov_b32 v151, v133
  v_mov_b32 v152, v134
  v_mov_b32 v153, v136
  v_mov_b32 v154, v137
  v_mov_b32 v155, v138
  v_mov_b32 v156, v140
  v_mov_b32 v157, v141
  s_mov_b32 s31, 0
L_slowsel:
  v_max_u32 v46, v144, v145
  v_max3_u32 v46, v46, v146, v147
  v_max3_u32 v46, v46, v148, v149
  v_max3_u32 v46, v46, v150, v151
  v_max3_u32 v46, v46, v152, v153
  v_max3_u32 v46, v46, v154, v155
  v_max3_u32 v46, v46, v156, v157
  s_nop 1
  v_max_u32_dpp v46, v46, v46 row_ror:1 row_mask:0xf bank_mask:0xf
  s_nop 1
  v_max_u32_dpp v46, v46, v46 row_ror:2 row_mask:0xf bank_mask:0xf
  s_nop 1
  v_max_u32_dpp v46, v46, v46 row_ror:4 row_mask:0xf bank_mask:0xf
  s_nop 1
  v_max_u32_dpp v46, v46, v46 row_ror:8 row_mask:0xf bank_mask:0xf
  s_nop 1
  v_readlane_b32 s32, v46, 0
  v_readlane_b32 s33, v46, 16
  v_readlane_b32 s34, v46, 32
  v_readlane_b32 s35, v46, 48
  s_nop 3
  s_max_u32 s32, s32, s33
  s_max_u32 s34, s34, s35
  s_max_u32 s32, s32, s34
  v_mov_b32 v75, s32
  v_cmp_eq_u32 vcc, s32, v144
  s_nop 1
  v_cndmask_b32 v144, v144, 0, vcc
  v_cmp_eq_u32 vcc, s32, v145
  s_nop 1
  v_cndmask_b32 v145, v145, 0, vcc
  v_cmp_eq_u32 vcc, s32, v146
  s_nop 1
  v_cndmask_b32 v146, v146, 0, vcc
  v_cmp_eq_u32 vcc, s32, v147
  s_nop 1
  v_cndmask_b32 v147, v147, 0, vcc
  v_cmp_eq_u32 vcc, s32, v148
  s_nop 1
  v_cndmask_b32 v148, v148, 0, vcc
  v_cmp_eq_u32 vcc, s32, v149
  s_nop 1
  v_cndmask_b32 v149, v149, 0, vcc
  v_cmp_eq_u32 vcc, s32, v150
  s_nop 1
  v_cndmask_b32 v150, v150, 0, vcc
  v_cmp_eq_u32 vcc, s32, v151
  s_nop 1
  v_cndmask_b32 v151, v151, 0, vcc
  v_cmp_eq_u32 vcc, s32, v152
  s_nop 1
  v_cndmask_b32 v152, v152, 0, vcc
  v_cmp_eq_u32 vcc, s32, v153
  s_nop 1
  v_cndmask_b32 v153, v153, 0, vcc
  v_cmp_eq_u32 vcc, s32, v154
  s_nop 1
  v_cndmask_b32 v154, v154, 0, vcc
  v_cmp_eq_u32 vcc, s32, v155
  s_nop 1
  v_cndmask_b32 v155, v155, 0, vcc
  v_cmp_eq_u32 vcc, s32, v156
  s_nop 1
  v_cndmask_b32 v156, v156, 0, vcc
  v_cmp_eq_u32 vcc, s32, v157
  s_nop 1
  v_cndmask_b32 v157, v157, 0, vcc
  v_cmp_eq_u32 vcc, s31, v199
  s_nop 1
  v_cndmask_b32 v72, v72, v75, vcc
  v_cmp_eq_u32 vcc, s31, v198
  s_nop 1
  v_cndmask_b32 v73, v73, v75, vcc
  s_add_u32 s31, s31, 1
  s_cmp_lt_u32 s31, 8
  s_cbranch_scc1 L_slowsel
  v_cmp_le_u32 vcc, s32, v126
  s_cbranch_vccz L_sn0
  s_ff1_i32_b64 s33, vcc
  s_lshl_b64 s[34:35], 1, s33
  v_readlane_b32 s33, v126, s33
  s_mov_b64 exec, s[34:35]
  v_mov_b32 v124, 0
  v_mov_b32 v125, 0
  v_mov_b32 v126, 0
  s_mov_b64 exec, -1
  s_branch L_redo
L_sn0:
  v_cmp_le_u32 vcc, s32, v130
  s_cbranch_vccz L_sn1
  s_ff1_i32_b64 s33, vcc
  s_lshl_b64 s[34:35], 1, s33
  v_readlane_b32 s33, v130, s33
  s_mov_b64 exec, s[34:35]
  v_mov_b32 v128, 0
  v_mov_b32 v129, 0
  v_mov_b32 v130, 0
  s_mov_b64 exec, -1
  s_branch L_redo
L_sn1:
  v_cmp_le_u32 vcc, s32, v134
  s_cbranch_vccz L_sn2
  s_ff1_i32_b64 s33, vcc
  s_lshl_b64 s[34:35], 1, s33
  v_readlane_b32 s33, v134, s33
  s_mov_b64 exec, s[34:35]
  v_mov_b32 v132, 0
  v_mov_b32 v133, 0
  v_mov_b32 v134, 0
  s_mov_b64 exec, -1
  s_branch L_redo
L_sn2:
  v_cmp_le_u32 vcc, s32, v138
  s_cbranch_vccz L_sn3
  s_ff1_i32_b64 s33, vcc
  s_lshl_b64 s[34:35], 1, s33
  v_readlane_b32 s33, v138, s33
  s_mov_b64 exec, s[34:35]
  v_mov_b32 v136, 0
  v_mov_b32 v137, 0
  v_mov_b32 v138, 0
  s_mov_b64 exec, -1
  s_branch L_redo
L_sn3:
  s_branch L_seldone
L_redo:
  s_bfe_u32 s33, s33, 0xb0005
  s_sub_u32 s33, 2047, s33
  s_and_b32 s33, s33, 0x7f8
  v_add_u32 v196, s33, v3
  v_mul_u32_u24 v197, 1152, v196
  v_lshlrev_b32 v142, 4, v2
  v_add_u32 v197, v197, v142
  global_load_dwordx4 v[160:163], v197, s[4:5] offset:0
  global_load_dwordx4 v[164:167], v197, s[4:5] offset:128
  global_load_dwordx4 v[168:171], v197, s[4:5] offset:256
  global_load_dwordx4 v[172:175], v197, s[4:5] offset:384
  global_load_dwordx4 v[176:179], v197, s[4:5] offset:512
  global_load_dwordx4 v[180:183], v197, s[4:5] offset:640
  global_load_dwordx4 v[184:187], v197, s[4:5] offset:768
  global_load_dwordx4 v[188:191], v197, s[4:5] offset:896
  global_load_dwordx4 v[192:195], v197, s[4:5] offset:1024
  v_mov_b32 v46, v72
  v_mov_b32 v143, 0
  v_sub_u32 v196, 2047, v196
  v_lshlrev_b32 v196, 5, v196
  v_mov_b32 v197, v142
  v_mov_b32 v142, 0
  s_waitcnt vmcnt(0)
  ds_read_b128 v[48:51], v197 offset:12096
  s_waitcnt lgkmcnt(0)
  v_dot2c_f32_bf16 v142, v160, v48
  v_dot2c_f32_bf16 v143, v161, v49
  v_dot2c_f32_bf16 v142, v162, v50
  v_dot2c_f32_bf16 v143, v163, v51
  s_nop 2
  ds_read_b128 v[48:51], v197 offset:12224
  s_waitcnt lgkmcnt(0)
  v_dot2c_f32_bf16 v142, v164, v48
  v_dot2c_f32_bf16 v143, v165, v49
  v_dot2c_f32_bf16 v142, v166, v50
  v_dot2c_f32_bf16 v143, v167, v51
  s_nop 2
  ds_read_b128 v[48:51], v197 offset:12352
  s_waitcnt lgkmcnt(0)
  v_dot2c_f32_bf16 v142, v168, v48
  v_dot2c_f32_bf16 v143, v169, v49
  v_dot2c_f32_bf16 v142, v170, v50
  v_dot2c_f32_bf16 v143, v171, v51
  s_nop 2
  ds_read_b128 v[48:51], v197 offset:12480
  s_waitcnt lgkmcnt(0)
  v_dot2c_f32_bf16 v142, v172, v48
  v_dot2c_f32_bf16 v143, v173, v49
  v_dot2c_f32_bf16 v142, v174, v50
  v_dot2c_f32_bf16 v143, v175, v51
  s_nop 2
  ds_read_b128 v[48:51], v197 offset:12608
  s_waitcnt lgkmcnt(0)
  v_dot2c_f32_bf16 v142, v176, v48
  v_dot2c_f32_bf16 v143, v177, v49
  v_dot2c_f32_bf16 v142, v178, v50
  v_dot2c_f32_bf16 v143, v179, v51
  s_nop 2
  ds_read_b128 v[48:51], v197 offset:12736
  s_waitcnt lgkmcnt(0)
  v_dot2c_f32_bf16 v142, v180, v48
  v_dot2c_f32_bf16 v143, v181, v49
  v_dot2c_f32_bf16 v142, v182, v50
  v_dot2c_f32_bf16 v143, v183, v51
  s_nop 2
  ds_read_b128 v[48:51], v197 offset:12864
  s_waitcnt lgkmcnt(0)
  v_dot2c_f32_bf16 v142, v184, v48
  v_dot2c_f32_bf16 v143, v185, v49
  v_dot2c_f32_bf16 v142, v186, v50
  v_dot2c_f32_bf16 v143, v187, v51
  s_nop 2
  ds_read_b128 v[48:51], v197 offset:12992
  s_waitcnt lgkmcnt(0)
  v_dot2c_f32_bf16 v142, v188, v48
  v_dot2c_f32_bf16 v143, v189, v49
  v_dot2c_f32_bf16 v142, v190, v50
  v_dot2c_f32_bf16 v143, v191, v51
  s_nop 2
  ds_read_b128 v[48:51], v197 offset:13120
  s_waitcnt lgkmcnt(0)
  v_dot2c_f32_bf16 v142, v192, v48
  v_dot2c_f32_bf16 v143, v193, v49
  v_dot2c_f32_bf16 v142, v194, v50
  v_dot2c_f32_bf16 v143, v195, v51
  s_nop 2
  v_add_f32 v142, v142, v143
  s_nop 1
  v_add_f32_dpp v142, v142, v142 quad_perm:[1,0,3,2] row_mask:0xf bank_mask:0xf
  s_nop 1
  v_add_f32_dpp v142, v142, v142 quad_perm:[2,3,0,1] row_mask:0xf bank_mask:0xf
  s_nop 1
  v_add_f32_dpp v142, v142, v142 row_half_mirror row_mask:0xf bank_mask:0xf
  v_cvt_pk_bf16_f32 v143, v142, v142
  v_cmp_u_f32 vcc, v142, v142
  v_ashrrev_i32 v48, 31, v143
  v_or_b32 v48, 0x80000000, v48
  v_xor_b32 v143, v143, v48
  v_cndmask_b32 v143, v143, 0, vcc
  s_mov_b32 s3, 0xffff0000
  v_and_or_b32 v143, v143, s3, v196
  v_mov_b32 v141, v140
  v_mov_b32 v140, v143
  s_branch L_slow_a
L_nanfix:
  s_waitcnt vmcnt(0)
  v_lshlrev_b32 v44, 16, v88
  v_and_b32 v45, 0xffff0000, v88
  v_fma_f32 v44, v44, 0, v44
  v_fma_f32 v45, v45, 0, v45
  v_cvt_pk_bf16_f32 v88, v44, v45
  v_lshlrev_b32 v44, 16, v89
  v_and_b32 v45, 0xffff0000, v89
  v_fma_f32 v44, v44, 0, v44
  v_fma_f32 v45, v45, 0, v45
  v_cvt_pk_bf16_f32 v89, v44, v45
  v_lshlrev_b32 v44, 16, v90
  v_and_b32 v45, 0xffff0000, v90
  v_fma_f32 v44, v44, 0, v44
  v_fma_f32 v45, v45, 0, v45
  v_cvt_pk_bf16_f32 v90, v44, v45
  v_lshlrev_b32 v44, 16, v91
  v_and_b32 v45, 0xffff0000, v91
  v_fma_f32 v44, v44, 0, v44
  v_fma_f32 v45, v45, 0, v45
  v_cvt_pk_bf16_f32 v91, v44, v45
  v_lshlrev_b32 v44, 16, v92
  v_and_b32 v45, 0xffff0000, v92
  v_fma_f32 v44, v44, 0, v44
  v_fma_f32 v45, v45, 0, v45
  v_cvt_pk_bf16_f32 v92, v44, v45
  v_lshlrev_b32 v44, 16, v93
  v_and_b32 v45, 0xffff0000, v93
  v_fma_f32 v44, v44, 0, v44
  v_fma_f32 v45, v45, 0, v45
  v_cvt_pk_bf16_f32 v93, v44, v45
  v_lshlrev_b32 v44, 16, v94
  v_and_b32 v45, 0xffff0000, v94
  v_fma_f32 v44, v44, 0, v44
  v_fma_f32 v45, v45, 0, v45
  v_cvt_pk_bf16_f32 v94, v44, v45
  v_lshlrev_b32 v44, 16, v95
  v_and_b32 v45, 0xffff0000, v95
  v_fma_f32 v44, v44, 0, v44
  v_fma_f32 v45, v45, 0, v45
  v_cvt_pk_bf16_f32 v95, v44, v45
  v_lshlrev_b32 v44, 16, v96
  v_and_b32 v45, 0xffff0000, v96
  v_fma_f32 v44, v44, 0, v44
  v_fma_f32 v45, v45, 0, v45
  v_cvt_pk_bf16_f32 v96, v44, v45
  v_lshlrev_b32 v44, 16, v97
  v_and_b32 v45, 0xffff0000, v97
  v_fma_f32 v44, v44, 0, v44
  v_fma_f32 v45, v45, 0, v45
  v_cvt_pk_bf16_f32 v97, v44, v45
  v_lshlrev_b32 v44, 16, v98
  v_and_b32 v45, 0xffff0000, v98
  v_fma_f32 v44, v44, 0, v44
  v_fma_f32 v45, v45, 0, v45
  v_cvt_pk_bf16_f32 v98, v44, v45
  v_lshlrev_b32 v44, 16, v99
  v_and_b32 v45, 0xffff0000, v99
  v_fma_f32 v44, v44, 0, v44
  v_fma_f32 v45, v45, 0, v45
  v_cvt_pk_bf16_f32 v99, v44, v45
  v_lshlrev_b32 v44, 16, v100
  v_and_b32 v45, 0xffff0000, v100
  v_fma_f32 v44, v44, 0, v44
  v_fma_f32 v45, v45, 0, v45
  v_cvt_pk_bf16_f32 v100, v44, v45
  v_lshlrev_b32 v44, 16, v101
  v_and_b32 v45, 0xffff0000, v101
  v_fma_f32 v44, v44, 0, v44
  v_fma_f32 v45, v45, 0, v45
  v_cvt_pk_bf16_f32 v101, v44, v45
  v_lshlrev_b32 v44, 16, v102
  v_and_b32 v45, 0xffff0000, v102
  v_fma_f32 v44, v44, 0, v44
  v_fma_f32 v45, v45, 0, v45
  v_cvt_pk_bf16_f32 v102, v44, v45
  v_lshlrev_b32 v44, 16, v103
  v_and_b32 v45, 0xffff0000, v103
  v_fma_f32 v44, v44, 0, v44
  v_fma_f32 v45, v45, 0, v45
  v_cvt_pk_bf16_f32 v103, v44, v45
  v_lshlrev_b32 v44, 16, v104
  v_and_b32 v45, 0xffff0000, v104
  v_fma_f32 v44, v44, 0, v44
  v_fma_f32 v45, v45, 0, v45
  v_cvt_pk_bf16_f32 v104, v44, v45
  v_lshlrev_b32 v44, 16, v105
  v_and_b32 v45, 0xffff0000, v105
  v_fma_f32 v44, v44, 0, v44
  v_fma_f32 v45, v45, 0, v45
  v_cvt_pk_bf16_f32 v105, v44, v45
  v_lshlrev_b32 v44, 16, v106
  v_and_b32 v45, 0xffff0000, v106
  v_fma_f32 v44, v44, 0, v44
  v_fma_f32 v45, v45, 0, v45
  v_cvt_pk_bf16_f32 v106, v44, v45
  v_lshlrev_b32 v44, 16, v107
  v_and_b32 v45, 0xffff0000, v107
  v_fma_f32 v44, v44, 0, v44
  v_fma_f32 v45, v45, 0, v45
  v_cvt_pk_bf16_f32 v107, v44, v45
  v_lshlrev_b32 v44, 16, v108
  v_and_b32 v45, 0xffff0000, v108
  v_fma_f32 v44, v44, 0, v44
  v_fma_f32 v45, v45, 0, v45
  v_cvt_pk_bf16_f32 v108, v44, v45
  v_lshlrev_b32 v44, 16, v109
  v_and_b32 v45, 0xffff0000, v109
  v_fma_f32 v44, v44, 0, v44
  v_fma_f32 v45, v45, 0, v45
  v_cvt_pk_bf16_f32 v109, v44, v45
  v_lshlrev_b32 v44, 16, v110
  v_and_b32 v45, 0xffff0000, v110
  v_fma_f32 v44, v44, 0, v44
  v_fma_f32 v45, v45, 0, v45
  v_cvt_pk_bf16_f32 v110, v44, v45
  v_lshlrev_b32 v44, 16, v111
  v_and_b32 v45, 0xffff0000, v111
  v_fma_f32 v44, v44, 0, v44
  v_fma_f32 v45, v45, 0, v45
  v_cvt_pk_bf16_f32 v111, v44, v45
  v_lshlrev_b32 v44, 16, v112
  v_and_b32 v45, 0xffff0000, v112
  v_fma_f32 v44, v44, 0, v44
  v_fma_f32 v45, v45, 0, v45
  v_cvt_pk_bf16_f32 v112, v44, v45
  v_lshlrev_b32 v44, 16, v113
  v_and_b32 v45, 0xffff0000, v113
  v_fma_f32 v44, v44, 0, v44
  v_fma_f32 v45, v45, 0, v45
  v_cvt_pk_bf16_f32 v113, v44, v45
  v_lshlrev_b32 v44, 16, v114
  v_and_b32 v45, 0xffff0000, v114
  v_fma_f32 v44, v44, 0, v44
  v_fma_f32 v45, v45, 0, v45
  v_cvt_pk_bf16_f32 v114, v44, v45
  v_lshlrev_b32 v44, 16, v115
  v_and_b32 v45, 0xffff0000, v115
  v_fma_f32 v44, v44, 0, v44
  v_fma_f32 v45, v45, 0, v45
  v_cvt_pk_bf16_f32 v115, v44, v45
  v_lshlrev_b32 v44, 16, v116
  v_and_b32 v45, 0xffff0000, v116
  v_fma_f32 v44, v44, 0, v44
  v_fma_f32 v45, v45, 0, v45
  v_cvt_pk_bf16_f32 v116, v44, v45
  v_lshlrev_b32 v44, 16, v117
  v_and_b32 v45, 0xffff0000, v117
  v_fma_f32 v44, v44, 0, v44
  v_fma_f32 v45, v45, 0, v45
  v_cvt_pk_bf16_f32 v117, v44, v45
  v_lshlrev_b32 v44, 16, v118
  v_and_b32 v45, 0xffff0000, v118
  v_fma_f32 v44, v44, 0, v44
  v_fma_f32 v45, v45, 0, v45
  v_cvt_pk_bf16_f32 v118, v44, v45
  v_lshlrev_b32 v44, 16, v119
  v_and_b32 v45, 0xffff0000, v119
  v_fma_f32 v44, v44, 0, v44
  v_fma_f32 v45, v45, 0, v45
  v_cvt_pk_bf16_f32 v119, v44, v45
  v_lshlrev_b32 v44, 16, v120
  v_and_b32 v45, 0xffff0000, v120
  v_fma_f32 v44, v44, 0, v44
  v_fma_f32 v45, v45, 0, v45
  v_cvt_pk_bf16_f32 v120, v44, v45
  v_lshlrev_b32 v44, 16, v121
  v_and_b32 v45, 0xffff0000, v121
  v_fma_f32 v44, v44, 0, v44
  v_fma_f32 v45, v45, 0, v45
  v_cvt_pk_bf16_f32 v121, v44, v45
  v_lshlrev_b32 v44, 16, v122
  v_and_b32 v45, 0xffff0000, v122
  v_fma_f32 v44, v44, 0, v44
  v_fma_f32 v45, v45, 0, v45
  v_cvt_pk_bf16_f32 v122, v44, v45
  v_lshlrev_b32 v44, 16, v123
  v_and_b32 v45, 0xffff0000, v123
  v_fma_f32 v44, v44, 0, v44
  v_fma_f32 v45, v45, 0, v45
  v_cvt_pk_bf16_f32 v123, v44, v45
  s_branch L_copy
.section .rodata,"a"
.p2align 6
.amdhsa_kernel standalone__moe_arch_mod__prompt_kernel
  .amdhsa_next_free_vgpr 216
  .amdhsa_next_free_sgpr 96
  .amdhsa_accum_offset 216
  .amdhsa_group_segment_fixed_size 0
  .amdhsa_kernarg_size 64
  .amdhsa_user_sgpr_count 2
  .amdhsa_user_sgpr_kernarg_segment_ptr 1
  .amdhsa_system_sgpr_workgroup_id_x 1
  .amdhsa_float_denorm_mode_32 3
.end_amdhsa_kernel
.text
```
